```python
import torch

def _softmax(x, axis=-1):
    return torch.softmax(x, dim=axis)

def _gelu(x):
    return torch.nn.functional.gelu(x, approximate='tanh')

def _silu(x):
    return torch.nn.functional.silu(x)

def _sigmoid(x):
    return torch.sigmoid(x)

def _layernorm(x, axis=-1, eps=1e-05):
    m = x.mean(dim=axis, keepdim=True)
    v = x.var(dim=axis, keepdim=True, unbiased=False)
    return (x - m) / torch.sqrt(v + eps)

def _scatter_add(tgt, idx, src, axis=0):
    return tgt.clone().index_add_(axis, idx, src)

def _segment_sum(src, seg, n):
    out = torch.zeros((n,) + src.shape[1:], dtype=src.dtype)
    return out.index_add_(0, seg, src)

def _pad(x, pw):
    flat = tuple((v for pair in reversed(pw) for v in pair))
    return torch.nn.functional.pad(x, flat)
kernel_name = 'adaLN_cond__spectral_gfnet__dense_activation_silu__prompt'

def setup_inputs():

    _w = lambda a: (lambda t: t.to(torch.bfloat16) if t.is_floating_point() else t)(torch.as_tensor(a))

    def _A_setup():
        B, S, D = (1, 2048, 512)
        Df = D // 2 + 1
        return {'x': _w((lambda *s: torch.randn(*s, dtype=torch.bfloat16) * 0.05)(B, S, D)), 'w_r': _w((lambda *s: torch.randn(*s, dtype=torch.bfloat16) * 1.6)(S, Df) * 0.02), 'w_i': _w((lambda *s: torch.randn(*s, dtype=torch.bfloat16) * 1.6)(S, Df) * 0.02)}
    _A_in = _A_setup()

    def _B_setup():
        B, S, D, F = (1, 2048, 512, 1376)
        return {'x': _w((lambda *s: torch.randn(*s, dtype=torch.bfloat16) * 0.05)(B, S, D)), 'w1': _w((lambda *s: torch.randn(*s, dtype=torch.bfloat16) * 0.8)(D, F) * D ** (-0.5)), 'w2': _w((lambda *s: torch.randn(*s, dtype=torch.bfloat16) * 0.2)(F, D) * F ** (-0.5))}
    _B_in = _B_setup()
    return {'A_x': _A_in['x'], 'A_w_r': _A_in['w_r'], 'A_w_i': _A_in['w_i'], 'B_x': _B_in['x'], 'B_w1': _B_in['w1'], 'B_w2': _B_in['w2'], 'c': _w((lambda *s: torch.randn(*s, dtype=torch.bfloat16) * 0.2)(1, 512) * 8.0), 'w_mod': _w((lambda *s: torch.randn(*s, dtype=torch.bfloat16) * 0.2)(512, 6 * 512) * 512 ** (-0.5) * 8.0)}

def reference(A_x, A_w_r, A_w_i, B_x, B_w1, B_w2, c, w_mod):

    def _A_ref(x, w_r, w_i):
        B, S, D = x.shape
        X = (lambda x, axes=(-2, -1): torch.fft.rfft2(x.float(), dim=axes))(x, axes=(-2, -1))
        W = w_r + 1j * w_i
        X = X * W
        y = (lambda x, s, axes=(-2, -1): torch.fft.irfft2(x, s=s, dim=axes).to(torch.bfloat16))(X, (S, D), axes=(-2, -1))
        return y

    def _B_ref(x, w1, w2):
        h = torch.einsum('bsd,df->bsf', x, w1)
        h = _silu(h)
        out = torch.einsum('bsf,fd->bsd', h, w2)
        return out
    x = A_x
    mod = (_silu(c) @ w_mod).reshape(c.shape[0], 6, 1, -1)
    sa, ca, ga, sb, cb, gb = (mod[:, 0].clone(), mod[:, 1].clone(), mod[:, 2].clone(), mod[:, 3].clone(), mod[:, 4].clone(), mod[:, 5].clone())
    h = _layernorm(x, axis=-1) * (1 + ca) + sa
    x = x + ga * _A_ref(h, A_w_r, A_w_i)
    h = _layernorm(x, axis=-1) * (1 + cb) + sb
    x = x + gb * _B_ref(h, B_w1, B_w2)
    return x
```

```asm
; @launch grid=(256,1,1) block=(512,1,1) lds=163840
.amdgcn_target "amdgcn-amd-amdhsa--gfx950"
.text
.globl adaLN_cond__spectral_gfnet__dense_activation_silu__prompt_kernel
.p2align 8
.type adaLN_cond__spectral_gfnet__dense_activation_silu__prompt_kernel,@function
adaLN_cond__spectral_gfnet__dense_activation_silu__prompt_kernel:
    s_cmp_ge_u32 s2, 256
    s_cbranch_scc1 cde_end
    s_load_dwordx4 s[40:43], s[0:1], 48
    s_load_dwordx2 s[8:9], s[0:1], 80
    s_load_dwordx2 s[4:5], s[0:1], 0
    s_load_dwordx2 s[6:7], s[0:1], 64
    s_load_dwordx4 s[52:55], s[0:1], 32
    s_load_dwordx4 s[44:47], s[0:1], 8
    s_load_dwordx2 s[62:63], s[0:1], 72
    v_and_b32 v1, 63, v0
    v_lshrrev_b32 v2, 6, v0
    v_lshlrev_b32 v3, 4, v1
    v_readfirstlane_b32 s23, v2
    s_getpc_b64 s[24:25]
cde_pc1:
    s_sub_u32 s24, s24, cde_pc1-adaLN_cond__spectral_gfnet__dense_activation_silu__prompt_kernel
    s_subb_u32 s25, s25, 0
    s_cmp_eq_u32 s23, 5
    s_cbranch_scc0 cde_nct
    s_bfe_u32 s57, s2, 0x20003
    v_lshl_add_u32 v48, v1, 2, s57
    v_lshlrev_b32 v48, 7, v48
    v_min_u32 v48, cde_last-128-adaLN_cond__spectral_gfnet__dense_activation_silu__prompt_kernel, v48
    global_load_dword v49, v48, s[24:25]
cde_nct:
    s_and_b32 s14, s2, 7
    s_lshl_b32 s14, s14, 5
    s_lshr_b32 s3, s2, 3
    s_add_u32 s14, s14, s3
    v_mov_b32 v28, 110592
    v_mov_b32 v11, 1
    s_getreg_b32 s56, hwreg(HW_REG_XCC_ID)
    s_or_b32 s56, s56, 0x100
    s_cmp_ge_u32 s23, 4
    s_cbranch_scc1 cde_L
    v_mov_b32 v224, v28
    v_mov_b32 v16, 0
    v_lshl_add_u32 v17, v1, 2, v28
    ds_write_b32 v17, v16
    s_lshl_b32 s15, s14, 11
    v_lshl_add_u32 v7, v2, 19, v3
    v_add_u32 v7, s15, v7
    v_lshlrev_b32 v8, 7, v0
    s_lshl_b32 s15, s14, 13
    v_lshlrev_b32 v9, 4, v0
    v_add_u32 v9, s15, v9
    v_add_u32 v9, 4194304, v9
    v_add_u32 v10, 4096, v9
    v_add_u32 v4, 2097152, v9
    v_add_u32 v5, 2097152, v10
    s_lshl_b32 s15, s14, 7
    s_lshl_b32 s57, s23, 4
    s_add_u32 s15, s15, s57
    s_add_u32 s15, s15, 32768
    v_mov_b32 v6, s15
    s_waitcnt lgkmcnt(0)
    global_load_dwordx4 v[12:15], v7, s[4:5]
    global_load_dwordx4 v[16:19], v7, s[4:5] offset:1024
    s_barrier
    v_mov_b32 v225, v4
    v_mov_b32 v226, v5
    v_mov_b32 v227, v6
    v_and_b32 v9, 15, v1
    v_lshl_add_u32 v9, v2, 4, v9
    v_lshrrev_b32 v5, 4, v1
    v_lshrrev_b32 v4, 1, v9
    v_sub_u32 v10, 63, v4
    v_lshl_add_u32 v208, v5, 6, v4
    v_lshl_add_u32 v209, v5, 6, v10
    v_add_u32 v10, 1, v10
    v_cmp_eq_u32 vcc, 0, v4
    s_nop 1
    v_cndmask_b32 v10, v10, 32, vcc
    v_cmp_eq_u32 vcc, 1, v9
    s_nop 1
    v_cndmask_b32 v208, v208, v209, vcc
    v_add_u32 v210, 1, v209
    v_and_b32 v210, 255, v210
    v_cmp_eq_u32 vcc, 0, v9
    s_nop 1
    v_cndmask_b32 v209, v209, v210, vcc
    v_and_b32 v210, 1, v9
    v_cmp_eq_u32 vcc, 1, v210
    s_nop 1
    v_cndmask_b32 v4, v4, v10, vcc
    v_cvt_f32_u32 v28, v4
    v_cvt_f32_u32 v29, v5
    v_mul_f32 v30, 0x3c800000, v28
    v_mul_f32 v31, v30, v29
    v_mul_f32 v31, 0x41000000, v31
    v_cos_f32 v21, v31
    v_sin_f32 v22, v31
    v_fmamk_f32 v20, v30, 0x3f800000, v31
    v_cos_f32 v23, v20
    v_sin_f32 v24, v20
    v_cvt_pk_bf16_f32 v32, v21, v23
    v_cvt_pk_bf16_f32 v40, v22, v24
    v_cvt_pk_bf16_f32 v48, -v22, -v24
    v_fmamk_f32 v20, v30, 0x40000000, v31
    v_cos_f32 v21, v20
    v_sin_f32 v22, v20
    v_fmamk_f32 v20, v30, 0x40400000, v31
    v_cos_f32 v23, v20
    v_sin_f32 v24, v20
    v_cvt_pk_bf16_f32 v33, v21, v23
    v_cvt_pk_bf16_f32 v41, v22, v24
    v_cvt_pk_bf16_f32 v49, -v22, -v24
    v_fmamk_f32 v20, v30, 0x40800000, v31
    v_cos_f32 v21, v20
    v_sin_f32 v22, v20
    v_fmamk_f32 v20, v30, 0x40a00000, v31
    v_cos_f32 v23, v20
    v_sin_f32 v24, v20
    v_cvt_pk_bf16_f32 v34, v21, v23
    v_cvt_pk_bf16_f32 v42, v22, v24
    v_cvt_pk_bf16_f32 v50, -v22, -v24
    v_fmamk_f32 v20, v30, 0x40c00000, v31
    v_cos_f32 v21, v20
    v_sin_f32 v22, v20
    v_fmamk_f32 v20, v30, 0x40e00000, v31
    v_cos_f32 v23, v20
    v_sin_f32 v24, v20
    v_cvt_pk_bf16_f32 v35, v21, v23
    v_cvt_pk_bf16_f32 v43, v22, v24
    v_cvt_pk_bf16_f32 v51, -v22, -v24
    v_fmamk_f32 v20, v30, 0x42000000, v31
    v_cos_f32 v21, v20
    v_sin_f32 v22, v20
    v_fmamk_f32 v20, v30, 0x42040000, v31
    v_cos_f32 v23, v20
    v_sin_f32 v24, v20
    v_cvt_pk_bf16_f32 v36, v21, v23
    v_cvt_pk_bf16_f32 v44, v22, v24
    v_cvt_pk_bf16_f32 v52, -v22, -v24
    v_fmamk_f32 v20, v30, 0x42080000, v31
    v_cos_f32 v21, v20
    v_sin_f32 v22, v20
    v_fmamk_f32 v20, v30, 0x420c0000, v31
    v_cos_f32 v23, v20
    v_sin_f32 v24, v20
    v_cvt_pk_bf16_f32 v37, v21, v23
    v_cvt_pk_bf16_f32 v45, v22, v24
    v_cvt_pk_bf16_f32 v53, -v22, -v24
    v_fmamk_f32 v20, v30, 0x42100000, v31
    v_cos_f32 v21, v20
    v_sin_f32 v22, v20
    v_fmamk_f32 v20, v30, 0x42140000, v31
    v_cos_f32 v23, v20
    v_sin_f32 v24, v20
    v_cvt_pk_bf16_f32 v38, v21, v23
    v_cvt_pk_bf16_f32 v46, v22, v24
    v_cvt_pk_bf16_f32 v54, -v22, -v24
    v_fmamk_f32 v20, v30, 0x42180000, v31
    v_cos_f32 v21, v20
    v_sin_f32 v22, v20
    v_fmamk_f32 v20, v30, 0x421c0000, v31
    v_cos_f32 v23, v20
    v_sin_f32 v24, v20
    v_cvt_pk_bf16_f32 v39, v21, v23
    v_cvt_pk_bf16_f32 v47, v22, v24
    v_cvt_pk_bf16_f32 v55, -v22, -v24
    v_and_b32 v20, 1, v5
    v_cvt_f32_u32 v25, v20
    v_mul_f32 v30, 0x3b000000, v28
    v_mul_f32 v20, v25, v30
    v_mul_f32 v20, 4.0, v20
    v_cos_f32 v56, v20
    v_sin_f32 v60, v20
    v_add_f32 v20, v20, v30
    v_cos_f32 v57, v20
    v_sin_f32 v61, v20
    v_add_f32 v20, v20, v30
    v_cos_f32 v58, v20
    v_sin_f32 v62, v20
    v_add_f32 v20, v20, v30
    v_cos_f32 v59, v20
    v_sin_f32 v63, v20
    v_bfe_u32 v20, v1, 2, 2
    v_cvt_f32_u32 v20, v20
    v_and_b32 v21, 1, v1
    v_cvt_f32_u32 v21, v21
    v_bfe_u32 v22, v1, 1, 1
    v_cvt_f32_u32 v22, v22
    v_lshrrev_b32 v23, 5, v1
    v_cvt_f32_u32 v23, v23
    v_mul_f32 v26, 0x3e000000, v20
    v_add_f32 v27, 0xbf600000, v26
    v_mul_f32 v21, 0x3e800000, v21
    v_mul_f32 v25, 4.0, v25
    v_fma_f32 v28, v25, v26, v21
    v_fma_f32 v29, v25, v27, v21
    v_mul_f32 v22, 0x3e800000, v22
    v_add_f32 v30, 0x0, v22
    v_add_f32 v31, 0x0, v23
    v_mul_f32 v24, v30, v31
    v_add_f32 v20, v24, v28
    v_cos_f32 v30, v20
    v_sin_f32 v31, v20
    s_nop 0
    v_cvt_pk_bf16_f32 v64, v30, v31
    v_add_f32 v20, v20, v26
    v_cos_f32 v30, v20
    v_sin_f32 v31, v20
    s_nop 0
    v_cvt_pk_bf16_f32 v65, v30, v31
    v_add_f32 v20, v20, v26
    v_cos_f32 v30, v20
    v_sin_f32 v31, v20
    s_nop 0
    v_cvt_pk_bf16_f32 v66, v30, v31
    v_add_f32 v20, v20, v26
    v_cos_f32 v30, v20
    v_sin_f32 v31, v20
    s_nop 0
    v_cvt_pk_bf16_f32 v67, v30, v31
    v_add_f32 v20, v24, v29
    v_cos_f32 v30, v20
    v_sin_f32 v31, v20
    s_nop 0
    v_cvt_pk_bf16_f32 v80, v30, -v31
    v_add_f32 v20, v20, v27
    v_cos_f32 v30, v20
    v_sin_f32 v31, v20
    s_nop 0
    v_cvt_pk_bf16_f32 v81, v30, -v31
    v_add_f32 v20, v20, v27
    v_cos_f32 v30, v20
    v_sin_f32 v31, v20
    s_nop 0
    v_cvt_pk_bf16_f32 v82, v30, -v31
    v_add_f32 v20, v20, v27
    v_cos_f32 v30, v20
    v_sin_f32 v31, v20
    s_nop 0
    v_cvt_pk_bf16_f32 v83, v30, -v31
    v_add_f32 v30, 0x0, v22
    v_add_f32 v31, 0x40000000, v23
    v_mul_f32 v24, v30, v31
    v_add_f32 v20, v24, v28
    v_cos_f32 v30, v20
    v_sin_f32 v31, v20
    s_nop 0
    v_cvt_pk_bf16_f32 v68, v30, v31
    v_add_f32 v20, v20, v26
    v_cos_f32 v30, v20
    v_sin_f32 v31, v20
    s_nop 0
    v_cvt_pk_bf16_f32 v69, v30, v31
    v_add_f32 v20, v20, v26
    v_cos_f32 v30, v20
    v_sin_f32 v31, v20
    s_nop 0
    v_cvt_pk_bf16_f32 v70, v30, v31
    v_add_f32 v20, v20, v26
    v_cos_f32 v30, v20
    v_sin_f32 v31, v20
    s_nop 0
    v_cvt_pk_bf16_f32 v71, v30, v31
    v_add_f32 v20, v24, v29
    v_cos_f32 v30, v20
    v_sin_f32 v31, v20
    s_nop 0
    v_cvt_pk_bf16_f32 v84, v30, -v31
    v_add_f32 v20, v20, v27
    v_cos_f32 v30, v20
    v_sin_f32 v31, v20
    s_nop 0
    v_cvt_pk_bf16_f32 v85, v30, -v31
    v_add_f32 v20, v20, v27
    v_cos_f32 v30, v20
    v_sin_f32 v31, v20
    s_nop 0
    v_cvt_pk_bf16_f32 v86, v30, -v31
    v_add_f32 v20, v20, v27
    v_cos_f32 v30, v20
    v_sin_f32 v31, v20
    s_nop 0
    v_cvt_pk_bf16_f32 v87, v30, -v31
    v_add_f32 v30, 0x3f000000, v22
    v_add_f32 v31, 0x0, v23
    v_mul_f32 v24, v30, v31
    v_add_f32 v20, v24, v28
    v_cos_f32 v30, v20
    v_sin_f32 v31, v20
    s_nop 0
    v_cvt_pk_bf16_f32 v72, v30, v31
    v_add_f32 v20, v20, v26
    v_cos_f32 v30, v20
    v_sin_f32 v31, v20
    s_nop 0
    v_cvt_pk_bf16_f32 v73, v30, v31
    v_add_f32 v20, v20, v26
    v_cos_f32 v30, v20
    v_sin_f32 v31, v20
    s_nop 0
    v_cvt_pk_bf16_f32 v74, v30, v31
    v_add_f32 v20, v20, v26
    v_cos_f32 v30, v20
    v_sin_f32 v31, v20
    s_nop 0
    v_cvt_pk_bf16_f32 v75, v30, v31
    v_add_f32 v20, v24, v29
    v_cos_f32 v30, v20
    v_sin_f32 v31, v20
    s_nop 0
    v_cvt_pk_bf16_f32 v88, v30, -v31
    v_add_f32 v20, v20, v27
    v_cos_f32 v30, v20
    v_sin_f32 v31, v20
    s_nop 0
    v_cvt_pk_bf16_f32 v89, v30, -v31
    v_add_f32 v20, v20, v27
    v_cos_f32 v30, v20
    v_sin_f32 v31, v20
    s_nop 0
    v_cvt_pk_bf16_f32 v90, v30, -v31
    v_add_f32 v20, v20, v27
    v_cos_f32 v30, v20
    v_sin_f32 v31, v20
    s_nop 0
    v_cvt_pk_bf16_f32 v91, v30, -v31
    v_add_f32 v30, 0x3f000000, v22
    v_add_f32 v31, 0x40000000, v23
    v_mul_f32 v24, v30, v31
    v_add_f32 v20, v24, v28
    v_cos_f32 v30, v20
    v_sin_f32 v31, v20
    s_nop 0
    v_cvt_pk_bf16_f32 v76, v30, v31
    v_add_f32 v20, v20, v26
    v_cos_f32 v30, v20
    v_sin_f32 v31, v20
    s_nop 0
    v_cvt_pk_bf16_f32 v77, v30, v31
    v_add_f32 v20, v20, v26
    v_cos_f32 v30, v20
    v_sin_f32 v31, v20
    s_nop 0
    v_cvt_pk_bf16_f32 v78, v30, v31
    v_add_f32 v20, v20, v26
    v_cos_f32 v30, v20
    v_sin_f32 v31, v20
    s_nop 0
    v_cvt_pk_bf16_f32 v79, v30, v31
    v_add_f32 v20, v24, v29
    v_cos_f32 v30, v20
    v_sin_f32 v31, v20
    s_nop 0
    v_cvt_pk_bf16_f32 v92, v30, -v31
    v_add_f32 v20, v20, v27
    v_cos_f32 v30, v20
    v_sin_f32 v31, v20
    s_nop 0
    v_cvt_pk_bf16_f32 v93, v30, -v31
    v_add_f32 v20, v20, v27
    v_cos_f32 v30, v20
    v_sin_f32 v31, v20
    s_nop 0
    v_cvt_pk_bf16_f32 v94, v30, -v31
    v_add_f32 v20, v20, v27
    v_cos_f32 v30, v20
    v_sin_f32 v31, v20
    s_nop 0
    v_cvt_pk_bf16_f32 v95, v30, -v31
    v_mov_b32 v28, 0x3b000000
    s_waitcnt vmcnt(0)
    v_lshlrev_b32 v112, 16, v12
    v_and_b32 v113, 0xffff0000, v12
    v_lshlrev_b32 v114, 16, v13
    v_and_b32 v115, 0xffff0000, v13
    v_lshlrev_b32 v116, 16, v14
    v_and_b32 v117, 0xffff0000, v14
    v_lshlrev_b32 v118, 16, v15
    v_and_b32 v119, 0xffff0000, v15
    v_lshlrev_b32 v120, 16, v16
    v_and_b32 v121, 0xffff0000, v16
    v_lshlrev_b32 v122, 16, v17
    v_and_b32 v123, 0xffff0000, v17
    v_lshlrev_b32 v124, 16, v18
    v_and_b32 v125, 0xffff0000, v18
    v_lshlrev_b32 v126, 16, v19
    v_and_b32 v127, 0xffff0000, v19
    v_pk_add_f32 v[12:13], v[112:113], v[114:115]
    v_pk_mul_f32 v[14:15], v[112:113], v[112:113]
    v_pk_add_f32 v[16:17], v[120:121], v[122:123]
    v_pk_mul_f32 v[18:19], v[120:121], v[120:121]
    v_pk_fma_f32 v[14:15], v[114:115], v[114:115], v[14:15]
    v_pk_fma_f32 v[18:19], v[122:123], v[122:123], v[18:19]
    v_pk_add_f32 v[12:13], v[12:13], v[116:117]
    v_pk_fma_f32 v[14:15], v[116:117], v[116:117], v[14:15]
    v_pk_add_f32 v[16:17], v[16:17], v[124:125]
    v_pk_fma_f32 v[18:19], v[124:125], v[124:125], v[18:19]
    v_pk_add_f32 v[12:13], v[12:13], v[118:119]
    v_pk_fma_f32 v[14:15], v[118:119], v[118:119], v[14:15]
    v_pk_add_f32 v[16:17], v[16:17], v[126:127]
    v_pk_fma_f32 v[18:19], v[126:127], v[126:127], v[18:19]
    v_add_f32 v20, v12, v13
    v_add_f32 v21, v14, v15
    v_add_f32 v22, v16, v17
    v_add_f32 v23, v18, v19
    v_add_f32_dpp v20, v20, v20 row_ror:8 row_mask:0xf bank_mask:0xf
    v_add_f32_dpp v21, v21, v21 row_ror:8 row_mask:0xf bank_mask:0xf
    v_add_f32_dpp v22, v22, v22 row_ror:8 row_mask:0xf bank_mask:0xf
    v_add_f32_dpp v23, v23, v23 row_ror:8 row_mask:0xf bank_mask:0xf
    v_add_f32_dpp v20, v20, v20 row_ror:4 row_mask:0xf bank_mask:0xf
    v_add_f32_dpp v21, v21, v21 row_ror:4 row_mask:0xf bank_mask:0xf
    v_add_f32_dpp v22, v22, v22 row_ror:4 row_mask:0xf bank_mask:0xf
    v_add_f32_dpp v23, v23, v23 row_ror:4 row_mask:0xf bank_mask:0xf
    v_add_f32_dpp v20, v20, v20 row_ror:2 row_mask:0xf bank_mask:0xf
    v_add_f32_dpp v21, v21, v21 row_ror:2 row_mask:0xf bank_mask:0xf
    v_add_f32_dpp v22, v22, v22 row_ror:2 row_mask:0xf bank_mask:0xf
    v_add_f32_dpp v23, v23, v23 row_ror:2 row_mask:0xf bank_mask:0xf
    v_add_f32_dpp v20, v20, v20 row_ror:1 row_mask:0xf bank_mask:0xf
    v_add_f32_dpp v21, v21, v21 row_ror:1 row_mask:0xf bank_mask:0xf
    v_add_f32_dpp v22, v22, v22 row_ror:1 row_mask:0xf bank_mask:0xf
    v_add_f32_dpp v23, v23, v23 row_ror:1 row_mask:0xf bank_mask:0xf
    v_add_f32_dpp v20, v20, v20 row_bcast:15 row_mask:0xa bank_mask:0xf
    v_add_f32_dpp v21, v21, v21 row_bcast:15 row_mask:0xa bank_mask:0xf
    v_add_f32_dpp v22, v22, v22 row_bcast:15 row_mask:0xa bank_mask:0xf
    v_add_f32_dpp v23, v23, v23 row_bcast:15 row_mask:0xa bank_mask:0xf
    v_add_f32_dpp v20, v20, v20 row_bcast:31 row_mask:0xc bank_mask:0xf
    v_add_f32_dpp v21, v21, v21 row_bcast:31 row_mask:0xc bank_mask:0xf
    v_add_f32_dpp v22, v22, v22 row_bcast:31 row_mask:0xc bank_mask:0xf
    v_add_f32_dpp v23, v23, v23 row_bcast:31 row_mask:0xc bank_mask:0xf
    v_readlane_b32 s36, v20, 63
    v_readlane_b32 s37, v21, 63
    v_readlane_b32 s38, v22, 63
    v_readlane_b32 s39, v23, 63
    v_pk_mul_f32 v[12:13], s[36:37], v[28:29] op_sel_hi:[1,0]
    s_nop 0
    v_pk_mul_f32 v[16:17], s[38:39], v[28:29] op_sel_hi:[1,0]
    v_fma_f32 v13, -v12, v12, v13
    v_fma_f32 v17, -v16, v16, v17
    v_max_f32 v13, 0, v13
    v_max_f32 v17, 0, v17
    v_add_f32 v13, 0x3727c5ac, v13
    v_add_f32 v17, 0x3727c5ac, v17
    v_rsq_f32 v14, v13
    v_rsq_f32 v18, v17
    v_mul_f32 v12, v12, v14
    v_mul_f32 v16, v16, v18
    v_pk_fma_f32 v[112:113], v[112:113], v[14:15], v[12:13] op_sel_hi:[1,0,0] neg_lo:[0,0,1] neg_hi:[0,0,1]
    v_pk_fma_f32 v[114:115], v[114:115], v[14:15], v[12:13] op_sel_hi:[1,0,0] neg_lo:[0,0,1] neg_hi:[0,0,1]
    v_pk_fma_f32 v[116:117], v[116:117], v[14:15], v[12:13] op_sel_hi:[1,0,0] neg_lo:[0,0,1] neg_hi:[0,0,1]
    v_pk_fma_f32 v[118:119], v[118:119], v[14:15], v[12:13] op_sel_hi:[1,0,0] neg_lo:[0,0,1] neg_hi:[0,0,1]
    v_pk_fma_f32 v[120:121], v[120:121], v[18:19], v[16:17] op_sel_hi:[1,0,0] neg_lo:[0,0,1] neg_hi:[0,0,1]
    v_pk_fma_f32 v[122:123], v[122:123], v[18:19], v[16:17] op_sel_hi:[1,0,0] neg_lo:[0,0,1] neg_hi:[0,0,1]
    v_pk_fma_f32 v[124:125], v[124:125], v[18:19], v[16:17] op_sel_hi:[1,0,0] neg_lo:[0,0,1] neg_hi:[0,0,1]
    v_pk_fma_f32 v[126:127], v[126:127], v[18:19], v[16:17] op_sel_hi:[1,0,0] neg_lo:[0,0,1] neg_hi:[0,0,1]
    v_and_b32 v212, 15, v1
    v_lshrrev_b32 v213, 4, v1
    v_cvt_f32_u32 v212, v212
    v_cvt_f32_u32 v213, v213
    v_cvt_f32_u32 v214, v2
    v_mul_f32 v213, 4.0, v213
    v_fma_f32 v215, v212, 4.0, v214
    v_fmamk_f32 v216, v213, 0x42800000, v215
    v_mul_f32 v216, 0x3a000000, v216
    v_cos_f32 v204, v216
    v_sin_f32 v200, v216
    v_add_f32 v216, 0x3d000000, v216
    v_cos_f32 v205, v216
    v_sin_f32 v201, v216
    v_add_f32 v216, 0x3d000000, v216
    v_cos_f32 v206, v216
    v_sin_f32 v202, v216
    v_add_f32 v216, 0x3d000000, v216
    v_cos_f32 v207, v216
    v_sin_f32 v203, v216
    v_mul_f32 v216, 0x3c800000, v215
    v_mul_f32 v217, v216, v213
    v_cos_f32 v218, v217
    v_sin_f32 v219, v217
    s_nop 0
    v_cvt_pk_bf16_f32 v160, v218, v219
    v_cvt_pk_bf16_f32 v164, -v219, v218
    v_add_f32 v217, v217, v216
    v_cos_f32 v218, v217
    v_sin_f32 v219, v217
    s_nop 0
    v_cvt_pk_bf16_f32 v161, v218, v219
    v_cvt_pk_bf16_f32 v165, -v219, v218
    v_add_f32 v217, v217, v216
    v_cos_f32 v218, v217
    v_sin_f32 v219, v217
    s_nop 0
    v_cvt_pk_bf16_f32 v162, v218, v219
    v_cvt_pk_bf16_f32 v166, -v219, v218
    v_add_f32 v217, v217, v216
    v_cos_f32 v218, v217
    v_sin_f32 v219, v217
    s_nop 0
    v_cvt_pk_bf16_f32 v163, v218, v219
    v_cvt_pk_bf16_f32 v167, -v219, v218
    v_mul_f32 v216, 0x3a800000, v215
    v_mul_f32 v217, v216, v213
    v_cos_f32 v184, v217
    v_sin_f32 v188, v217
    v_add_f32 v217, v217, v216
    v_cos_f32 v185, v217
    v_sin_f32 v189, v217
    v_add_f32 v217, v217, v216
    v_cos_f32 v186, v217
    v_sin_f32 v190, v217
    v_add_f32 v217, v217, v216
    v_cos_f32 v187, v217
    v_sin_f32 v191, v217
    v_mul_f32 v216, 0x3d800000, v212
    v_mul_f32 v217, v216, v213
    v_cos_f32 v218, v217
    v_sin_f32 v219, v217
    s_nop 0
    v_cvt_pk_bf16_f32 v168, v218, v219
    v_cvt_pk_bf16_f32 v172, -v219, v218
    v_add_f32 v217, v217, v216
    v_cos_f32 v218, v217
    v_sin_f32 v219, v217
    s_nop 0
    v_cvt_pk_bf16_f32 v169, v218, v219
    v_cvt_pk_bf16_f32 v173, -v219, v218
    v_add_f32 v217, v217, v216
    v_cos_f32 v218, v217
    v_sin_f32 v219, v217
    s_nop 0
    v_cvt_pk_bf16_f32 v170, v218, v219
    v_cvt_pk_bf16_f32 v174, -v219, v218
    v_add_f32 v217, v217, v216
    v_cos_f32 v218, v217
    v_sin_f32 v219, v217
    s_nop 0
    v_cvt_pk_bf16_f32 v171, v218, v219
    v_cvt_pk_bf16_f32 v175, -v219, v218
    v_fma_f32 v215, v213, 4.0, v214
    v_mul_f32 v215, v215, v212
    v_mul_f32 v216, 0x3d800000, v212
    v_mul_f32 v217, 0x3c800000, v215
    v_cos_f32 v218, v217
    v_sin_f32 v219, v217
    v_mul_f32 v218, 0x35800000, v218
    v_mul_f32 v219, 0x35800000, v219
    v_cvt_pk_bf16_f32 v176, v218, -v219
    v_cvt_pk_bf16_f32 v180, v219, v218
    v_add_f32 v217, v217, v216
    v_cos_f32 v218, v217
    v_sin_f32 v219, v217
    v_mul_f32 v218, 0x35800000, v218
    v_mul_f32 v219, 0x35800000, v219
    v_cvt_pk_bf16_f32 v177, v218, -v219
    v_cvt_pk_bf16_f32 v181, v219, v218
    v_add_f32 v217, v217, v216
    v_cos_f32 v218, v217
    v_sin_f32 v219, v217
    v_mul_f32 v218, 0x35800000, v218
    v_mul_f32 v219, 0x35800000, v219
    v_cvt_pk_bf16_f32 v178, v218, -v219
    v_cvt_pk_bf16_f32 v182, v219, v218
    v_add_f32 v217, v217, v216
    v_cos_f32 v218, v217
    v_sin_f32 v219, v217
    v_mul_f32 v218, 0x35800000, v218
    v_mul_f32 v219, 0x35800000, v219
    v_cvt_pk_bf16_f32 v179, v218, -v219
    v_cvt_pk_bf16_f32 v183, v219, v218
    v_mul_f32 v216, 0x3b800000, v212
    v_mul_f32 v217, 0x3a800000, v215
    v_cos_f32 v192, v217
    v_sin_f32 v196, v217
    v_add_f32 v217, v217, v216
    v_cos_f32 v193, v217
    v_sin_f32 v197, v217
    v_add_f32 v217, v217, v216
    v_cos_f32 v194, v217
    v_sin_f32 v198, v217
    v_add_f32 v217, v217, v216
    v_cos_f32 v195, v217
    v_sin_f32 v199, v217
    v_mul_u32_u24 v9, 2112, v2
    v_add_u32 v9, v9, v3
    v_add_u32 v9, 147456, v9
    v_bfe_u32 v10, v1, 1, 1
    v_mul_u32_u24 v10, 2112, v10
    v_and_b32 v6, 1, v1
    v_lshl_add_u32 v10, v6, 3, v10
    v_bfe_u32 v6, v1, 2, 2
    v_lshl_add_u32 v10, v6, 4, v10
    v_lshl_add_u32 v10, v5, 7, v10
    v_add_u32 v10, 147456, v10
    s_add_u32 s18, s8, 4194304
    s_addc_u32 s19, s9, 0
    s_add_u32 s12, s8, 65536
    s_addc_u32 s13, s9, 0
    s_lshl_b32 s15, s14, 13
    s_add_u32 s16, s18, s15
    s_addc_u32 s17, s19, 0
    v_lshlrev_b32 v4, 5, v208
    v_lshl_add_u32 v4, v210, 4, v4
    v_lshlrev_b32 v5, 5, v209
    v_xor_b32 v6, 1, v210
    v_lshl_add_u32 v5, v6, 4, v5
    v_mov_b32 v96, -1
    v_mov_b32 v97, -1
    v_mov_b32 v98, -1
    v_mov_b32 v99, -1
    v_mov_b32 v100, 0
    v_mov_b32 v101, 0
    v_mov_b32 v102, s56
    v_mov_b32 v103, 0
    global_store_dwordx4 v225, v[96:99], s[8:9] sc1
    global_store_dwordx4 v226, v[96:99], s[8:9] sc1
    s_mov_b64 exec, 1
    global_store_dwordx4 v227, v[100:103], s[8:9] sc1
    s_mov_b64 exec, -1
cde_lw2:
    ds_read_b32 v222, v224 offset:204
    s_waitcnt lgkmcnt(0)
    v_readfirstlane_b32 s15, v222
    s_nop 0
    s_cmp_ge_u32 s15, 1
    s_cbranch_scc0 cde_lw2
    s_mov_b32 s64, s15
    s_sleep 30
    global_load_dwordx4 v[96:99], v8, s[12:13] offset:0 sc1
    v_lshlrev_b32 v20, 3, v0
    v_add_u32 v20, 159744, v20
    v_add_u32 v21, 159744, v3
    s_movk_i32 s57, 0x3fff
    s_waitcnt vmcnt(0)
cde_m:
    v_xor_b32 v22, v96, v97
    v_xor_b32 v23, v98, v99
    v_xor_b32 v22, v22, v23
    v_xor_b32 v23, s64, v99
    v_or_b32 v22, v22, v23
    v_cmp_ne_u32 vcc, 0, v22
    s_cbranch_vccz cde_mok
    s_mov_b64 exec, vcc
    s_sleep 2
    global_load_dwordx4 v[96:99], v8, s[12:13] offset:0 sc1
    s_sub_u32 s57, s57, 1
    s_waitcnt vmcnt(0)
    s_cmp_lg_u32 s57, 0
    s_cbranch_scc1 cde_m
cde_mok:
    s_mov_b64 exec, -1
    ds_write_b64 v20, v[96:97]
    s_mov_b64 exec, 1
    ds_add_u32 v224, v11 offset:192
    s_mov_b64 exec, -1
cde_ml:
    ds_read_b32 v222, v224 offset:192
    ds_read_b128 v[96:99], v21
    ds_read_b128 v[100:103], v21 offset:1024
    s_waitcnt lgkmcnt(2)
    v_readfirstlane_b32 s15, v222
    s_nop 0
    s_cmp_ge_u32 s15, 4
    s_cbranch_scc0 cde_ml
    s_waitcnt lgkmcnt(0)
    v_lshlrev_b32 v128, 16, v96
    v_and_b32 v129, 0xffff0000, v96
    v_lshlrev_b32 v130, 16, v97
    v_and_b32 v131, 0xffff0000, v97
    v_lshlrev_b32 v132, 16, v98
    v_and_b32 v133, 0xffff0000, v98
    v_lshlrev_b32 v134, 16, v99
    v_and_b32 v135, 0xffff0000, v99
    v_lshlrev_b32 v136, 16, v100
    v_and_b32 v137, 0xffff0000, v100
    v_lshlrev_b32 v138, 16, v101
    v_and_b32 v139, 0xffff0000, v101
    v_lshlrev_b32 v140, 16, v102
    v_and_b32 v141, 0xffff0000, v102
    v_lshlrev_b32 v142, 16, v103
    v_and_b32 v143, 0xffff0000, v103
    v_pk_fma_f32 v[112:113], v[112:113], v[136:137], v[128:129]
    v_pk_fma_f32 v[114:115], v[114:115], v[138:139], v[130:131]
    v_pk_fma_f32 v[116:117], v[116:117], v[140:141], v[132:133]
    v_pk_fma_f32 v[118:119], v[118:119], v[142:143], v[134:135]
    v_cvt_pk_bf16_f32 v20, v112, v113
    v_cvt_pk_bf16_f32 v21, v114, v115
    v_cvt_pk_bf16_f32 v22, v116, v117
    v_cvt_pk_bf16_f32 v23, v118, v119
    ds_write_b128 v9, v[20:23] offset:0
    v_pk_fma_f32 v[120:121], v[120:121], v[136:137], v[128:129]
    v_pk_fma_f32 v[122:123], v[122:123], v[138:139], v[130:131]
    v_pk_fma_f32 v[124:125], v[124:125], v[140:141], v[132:133]
    v_pk_fma_f32 v[126:127], v[126:127], v[142:143], v[134:135]
    v_cvt_pk_bf16_f32 v24, v120, v121
    v_cvt_pk_bf16_f32 v25, v122, v123
    v_cvt_pk_bf16_f32 v26, v124, v125
    v_cvt_pk_bf16_f32 v27, v126, v127
    ds_write_b128 v9, v[24:27] offset:1056
    s_mov_b64 exec, 1
    ds_add_u32 v224, v11 offset:28
    s_mov_b64 exec, -1
cde_a1:
    ds_read_b32 v222, v224 offset:28
    ds_read_b64_tr_b16 v[96:97], v10 offset:0
    ds_read_b64_tr_b16 v[98:99], v10 offset:64
    ds_read_b64_tr_b16 v[100:101], v10 offset:4224
    ds_read_b64_tr_b16 v[102:103], v10 offset:4288
    ds_read_b64_tr_b16 v[104:105], v10 offset:512
    ds_read_b64_tr_b16 v[106:107], v10 offset:576
    ds_read_b64_tr_b16 v[108:109], v10 offset:4736
    ds_read_b64_tr_b16 v[110:111], v10 offset:4800
    ds_read_b64_tr_b16 v[112:113], v10 offset:1056
    ds_read_b64_tr_b16 v[114:115], v10 offset:1120
    ds_read_b64_tr_b16 v[116:117], v10 offset:5280
    ds_read_b64_tr_b16 v[118:119], v10 offset:5344
    s_waitcnt lgkmcnt(12)
    v_readfirstlane_b32 s15, v222
    s_nop 0
    s_cmp_ge_u32 s15, 4
    s_cbranch_scc0 cde_a1
    ds_read_b64_tr_b16 v[120:121], v10 offset:1568
    ds_read_b64_tr_b16 v[122:123], v10 offset:1632
    ds_read_b64_tr_b16 v[124:125], v10 offset:5792
    ds_read_b64_tr_b16 v[126:127], v10 offset:5856
    ds_read_b32 v223, v224 offset:56
    s_waitcnt lgkmcnt(13)
    v_mfma_f32_16x16x32_bf16 v[12:15], v[96:99], v[32:35], 0
    v_mfma_f32_16x16x32_bf16 v[16:19], v[96:99], v[48:51], 0
    v_mfma_f32_16x16x32_bf16 v[20:23], v[100:103], v[32:35], 0
    v_mfma_f32_16x16x32_bf16 v[24:27], v[100:103], v[48:51], 0
    s_waitcnt lgkmcnt(9)
    v_mfma_f32_16x16x32_bf16 v[12:15], v[104:107], v[36:39], v[12:15]
    v_mfma_f32_16x16x32_bf16 v[16:19], v[104:107], v[52:55], v[16:19]
    v_mfma_f32_16x16x32_bf16 v[20:23], v[108:111], v[36:39], v[20:23]
    v_mfma_f32_16x16x32_bf16 v[24:27], v[108:111], v[52:55], v[24:27]
    s_waitcnt lgkmcnt(5)
    v_mfma_f32_16x16x32_bf16 v[12:15], v[112:115], v[40:43], v[12:15]
    v_mfma_f32_16x16x32_bf16 v[16:19], v[112:115], v[32:35], v[16:19]
    v_mfma_f32_16x16x32_bf16 v[20:23], v[116:119], v[40:43], v[20:23]
    v_mfma_f32_16x16x32_bf16 v[24:27], v[116:119], v[32:35], v[24:27]
    s_waitcnt lgkmcnt(1)
    v_mfma_f32_16x16x32_bf16 v[12:15], v[120:123], v[44:47], v[12:15]
    v_mfma_f32_16x16x32_bf16 v[16:19], v[120:123], v[36:39], v[16:19]
    v_mfma_f32_16x16x32_bf16 v[20:23], v[124:127], v[44:47], v[20:23]
    v_mfma_f32_16x16x32_bf16 v[24:27], v[124:127], v[36:39], v[24:27]
    s_mov_b64 exec, 1
    ds_add_u32 v224, v11 offset:32
    s_mov_b64 exec, -1
    s_nop 1
    v_pk_mul_f32 v[96:97], v[12:13], v[56:57]
    v_pk_mul_f32 v[98:99], v[14:15], v[58:59]
    v_pk_mul_f32 v[100:101], v[16:17], v[56:57]
    v_pk_mul_f32 v[102:103], v[18:19], v[58:59]
    v_pk_fma_f32 v[96:97], v[16:17], v[60:61], v[96:97]
    v_pk_fma_f32 v[98:99], v[18:19], v[62:63], v[98:99]
    v_pk_fma_f32 v[100:101], v[12:13], v[60:61], v[100:101] neg_lo:[1,0,0] neg_hi:[1,0,0]
    v_pk_fma_f32 v[102:103], v[14:15], v[62:63], v[102:103] neg_lo:[1,0,0] neg_hi:[1,0,0]
    v_cvt_pk_bf16_f32 v112, v96, v100
    v_cvt_pk_bf16_f32 v113, v97, v101
    v_cvt_pk_bf16_f32 v114, v98, v102
    v_cvt_pk_bf16_f32 v115, v99, v103
    s_nop 1
    v_mfma_f32_16x16x32_bf16 v[32:35], v[64:67], v[112:115], 0
    v_mfma_f32_16x16x32_bf16 v[36:39], v[72:75], v[112:115], 0
    v_mfma_f32_16x16x32_bf16 v[40:43], v[80:83], v[112:115], 0
    v_mfma_f32_16x16x32_bf16 v[44:47], v[88:91], v[112:115], 0
    v_pk_mul_f32 v[104:105], v[20:21], v[56:57]
    v_pk_mul_f32 v[106:107], v[22:23], v[58:59]
    v_pk_mul_f32 v[108:109], v[24:25], v[56:57]
    v_pk_mul_f32 v[110:111], v[26:27], v[58:59]
    v_pk_fma_f32 v[104:105], v[24:25], v[60:61], v[104:105]
    v_pk_fma_f32 v[106:107], v[26:27], v[62:63], v[106:107]
    v_pk_fma_f32 v[108:109], v[20:21], v[60:61], v[108:109] neg_lo:[1,0,0] neg_hi:[1,0,0]
    v_pk_fma_f32 v[110:111], v[22:23], v[62:63], v[110:111] neg_lo:[1,0,0] neg_hi:[1,0,0]
    v_cvt_pk_bf16_f32 v116, v104, v108
    v_cvt_pk_bf16_f32 v117, v105, v109
    v_cvt_pk_bf16_f32 v118, v106, v110
    v_cvt_pk_bf16_f32 v119, v107, v111
    s_nop 1
    v_mfma_f32_16x16x32_bf16 v[32:35], v[68:71], v[116:119], v[32:35]
    v_mfma_f32_16x16x32_bf16 v[36:39], v[76:79], v[116:119], v[36:39]
    v_mfma_f32_16x16x32_bf16 v[40:43], v[84:87], v[116:119], v[40:43]
    v_mfma_f32_16x16x32_bf16 v[44:47], v[92:95], v[116:119], v[44:47]
    s_nop 4
    v_cvt_pk_bf16_f32 v96, v32, v33
    v_cvt_pk_bf16_f32 v97, v34, v35
    v_cvt_pk_bf16_f32 v98, v36, v37
    v_cvt_pk_bf16_f32 v99, v38, v39
    v_cvt_pk_bf16_f32 v100, v40, v41
    v_cvt_pk_bf16_f32 v101, v42, v43
    v_cvt_pk_bf16_f32 v102, v44, v45
    v_cvt_pk_bf16_f32 v103, v46, v47
    s_mov_b32 exec_lo, 0xaaaaaaaa
    s_mov_b32 exec_hi, 0xaaaaaaaa
    v_swap_b32 v96, v100
    v_swap_b32 v97, v101
    v_swap_b32 v98, v102
    v_swap_b32 v99, v103
    s_mov_b64 exec, -1
    s_waitcnt lgkmcnt(0)
    v_readfirstlane_b32 s15, v223
    s_nop 0
    s_cmp_ge_u32 s15, 4
    s_cbranch_scc1 cde_pd
cde_lw3:
    ds_read_b32 v222, v224 offset:56
    s_waitcnt lgkmcnt(0)
    v_readfirstlane_b32 s15, v222
    s_nop 0
    s_cmp_ge_u32 s15, 4
    s_cbranch_scc0 cde_lw3
cde_pd:
    global_store_dwordx4 v4, v[96:99], s[16:17] sc1
    global_store_dwordx4 v5, v[100:103], s[16:17] sc1
    v_and_b32 v7, 1, v0
    v_bfe_u32 v8, v0, 1, 2
    v_bfe_u32 v9, v0, 3, 4
    v_bfe_u32 v10, v0, 7, 1
    v_lshl_add_u32 v4, v10, 2, v8
    v_lshl_add_u32 v4, v4, 4, v9
    v_lshlrev_b32 v5, 13, v4
    v_lshl_add_u32 v5, v7, 4, v5
    s_lshl_b32 s15, s14, 5
    v_add_u32 v5, s15, v5
    v_add_u32 v6, 0x100000, v5
    v_lshlrev_b32 v4, 5, v4
    v_lshl_add_u32 v4, v7, 4, v4
    v_add_u32 v12, 4096, v4
    v_lshlrev_b32 v13, 12, v7
    v_lshl_add_u32 v13, v10, 8, v13
    v_lshl_add_u32 v13, v9, 4, v13
    v_lshl_add_u32 v13, v8, 2, v13
    v_add_u32 v13, 147456, v13
    s_add_u32 s20, s8, 6291456
    s_addc_u32 s21, s9, 0
    s_lshl_b32 s15, s14, 13
    s_add_u32 s26, s20, s15
    s_addc_u32 s27, s21, 0
    s_add_u32 s15, s15, 1048576
    v_lshlrev_b32 v8, 5, v1
    v_lshl_add_u32 v8, v2, 11, v8
    v_add_u32 v9, 3145728, v8
    v_add_u32 v8, s15, v8
    s_cmp_eq_u32 s14, 0
    s_cbranch_scc1 cde_sp1
cde_sp1r:
    v_lshl_add_u32 v10, v2, 10, v3
    v_add_u32 v10, 147456, v10
cde_lw4:
    ds_read_b32 v222, v224 offset:32
    s_waitcnt lgkmcnt(0)
    v_readfirstlane_b32 s15, v222
    s_nop 0
    s_cmp_ge_u32 s15, 4
    s_cbranch_scc0 cde_lw4
    s_waitcnt vmcnt(0)
    s_sleep 12
    global_load_dwordx4 v[24:27], v5, s[18:19] offset:0 sc1
    global_load_dwordx4 v[28:31], v6, s[18:19] offset:0 sc1
    s_sleep 1
    s_lshl_b32 s15, s14, 13
    s_add_u32 s15, s15, 1048576
    v_and_b32 v14, 15, v1
    v_lshl_add_u32 v14, v2, 4, v14
    v_lshl_add_u32 v14, v14, 7, s15
    global_load_dword v15, v14, s[8:9] sc1
    s_cmp_eq_u32 s14, 0
    s_cbranch_scc0 cde_nwt
    v_add_u32 v14, 0x200000, v14
    global_load_dword v16, v14, s[8:9] sc1
cde_nwt:
    s_movk_i32 s57, 0x3fff
    s_waitcnt vmcnt(1)
cde_pp:
    v_max3_u32 v222, v24, v25, v26
    v_max3_u32 v223, v27, v28, v29
    v_max3_u32 v222, v222, v30, v31
    v_max_u32 v222, v222, v223
    v_cmp_eq_u32 vcc, -1, v222
    s_cbranch_vccz cde_ppok
    s_mov_b64 exec, vcc
    s_sleep 2
    global_load_dwordx4 v[24:27], v5, s[18:19] offset:0 sc1
    global_load_dwordx4 v[28:31], v6, s[18:19] offset:0 sc1
    s_sub_u32 s57, s57, 1
    s_waitcnt vmcnt(00)
    s_cmp_lg_u32 s57, 0
    s_cbranch_scc1 cde_pp
cde_ppok:
    s_mov_b64 exec, -1
    ds_write_b32 v13, v24 offset:0
    ds_write_b32 v13, v25 offset:1024
    ds_write_b32 v13, v26 offset:2048
    ds_write_b32 v13, v27 offset:3072
    ds_write_b32 v13, v28 offset:512
    ds_write_b32 v13, v29 offset:1536
    ds_write_b32 v13, v30 offset:2560
    ds_write_b32 v13, v31 offset:3584
    s_mov_b64 exec, 1
    ds_add_u32 v224, v11 offset:0
    s_mov_b64 exec, -1
cde_b1:
    ds_read_b32 v222, v224
    ds_read_b128 v[24:27], v10
    ds_read_b128 v[28:31], v10 offset:4096
    s_waitcnt lgkmcnt(2)
    v_readfirstlane_b32 s15, v222
    s_nop 0
    s_cmp_ge_u32 s15, 4
    s_cbranch_scc0 cde_b1
    global_load_dwordx4 v[32:35], v8, s[8:9] offset:0 sc1
    global_load_dwordx4 v[36:39], v8, s[8:9] offset:16 sc1
    s_cmp_eq_u32 s14, 0
    s_cbranch_scc0 cde_nw2
    global_load_dwordx4 v[40:43], v9, s[8:9] offset:0 sc1
    global_load_dwordx4 v[44:47], v9, s[8:9] offset:16 sc1
cde_nw2:
    s_waitcnt lgkmcnt(1)
    v_mfma_f32_16x16x32_bf16 v[112:115], v[24:27], v[160:163], 0
    v_mfma_f32_16x16x32_bf16 v[116:119], v[24:27], v[164:167], 0
    s_waitcnt lgkmcnt(0)
    v_mfma_f32_16x16x32_bf16 v[120:123], v[28:31], v[160:163], 0
    v_mfma_f32_16x16x32_bf16 v[124:127], v[28:31], v[164:167], 0
    s_mov_b64 exec, 1
    ds_add_u32 v224, v11 offset:208
    s_mov_b64 exec, -1
    s_nop 0
    v_pk_mul_f32 v[128:129], v[112:113], v[184:185]
    v_pk_mul_f32 v[130:131], v[114:115], v[186:187]
    v_pk_mul_f32 v[132:133], v[116:117], v[184:185]
    v_pk_mul_f32 v[134:135], v[118:119], v[186:187]
    v_pk_fma_f32 v[128:129], v[116:117], v[188:189], v[128:129]
    v_pk_fma_f32 v[130:131], v[118:119], v[190:191], v[130:131]
    v_pk_fma_f32 v[132:133], v[112:113], v[188:189], v[132:133] neg_lo:[1,0,0] neg_hi:[1,0,0]
    v_pk_fma_f32 v[134:135], v[114:115], v[190:191], v[134:135] neg_lo:[1,0,0] neg_hi:[1,0,0]
    v_cvt_pk_bf16_f32 v24, v128, v132
    v_cvt_pk_bf16_f32 v25, v129, v133
    v_cvt_pk_bf16_f32 v26, v130, v134
    v_cvt_pk_bf16_f32 v27, v131, v135
    s_nop 1
    v_mfma_f32_16x16x32_bf16 v[112:115], v[168:171], v[24:27], 0
    v_mfma_f32_16x16x32_bf16 v[116:119], v[172:175], v[24:27], 0
    v_pk_mul_f32 v[136:137], v[120:121], v[184:185]
    v_pk_mul_f32 v[138:139], v[122:123], v[186:187]
    v_pk_mul_f32 v[140:141], v[124:125], v[184:185]
    v_pk_mul_f32 v[142:143], v[126:127], v[186:187]
    v_pk_fma_f32 v[136:137], v[124:125], v[188:189], v[136:137]
    v_pk_fma_f32 v[138:139], v[126:127], v[190:191], v[138:139]
    v_pk_fma_f32 v[140:141], v[120:121], v[188:189], v[140:141] neg_lo:[1,0,0] neg_hi:[1,0,0]
    v_pk_fma_f32 v[142:143], v[122:123], v[190:191], v[142:143] neg_lo:[1,0,0] neg_hi:[1,0,0]
    v_cvt_pk_bf16_f32 v28, v136, v140
    v_cvt_pk_bf16_f32 v29, v137, v141
    v_cvt_pk_bf16_f32 v30, v138, v142
    v_cvt_pk_bf16_f32 v31, v139, v143
    s_nop 1
    v_mfma_f32_16x16x32_bf16 v[120:123], v[168:171], v[28:31], 0
    v_mfma_f32_16x16x32_bf16 v[124:127], v[172:175], v[28:31], 0
    s_waitcnt vmcnt(0)
    v_lshlrev_b32 v144, 16, v32
    v_and_b32 v148, 0xffff0000, v32
    v_lshlrev_b32 v152, 16, v33
    v_and_b32 v156, 0xffff0000, v33
    v_lshlrev_b32 v145, 16, v34
    v_and_b32 v149, 0xffff0000, v34
    v_lshlrev_b32 v153, 16, v35
    v_and_b32 v157, 0xffff0000, v35
    v_lshlrev_b32 v146, 16, v36
    v_and_b32 v150, 0xffff0000, v36
    v_lshlrev_b32 v154, 16, v37
    v_and_b32 v158, 0xffff0000, v37
    v_lshlrev_b32 v147, 16, v38
    v_and_b32 v151, 0xffff0000, v38
    v_lshlrev_b32 v155, 16, v39
    v_and_b32 v159, 0xffff0000, v39
    v_pk_add_f32 v[104:105], v[144:145], v[152:153]
    v_pk_add_f32 v[106:107], v[146:147], v[154:155]
    v_pk_add_f32 v[108:109], v[148:149], v[156:157]
    v_pk_add_f32 v[110:111], v[150:151], v[158:159]
    v_pk_add_f32 v[144:145], v[144:145], v[152:153] neg_lo:[0,1] neg_hi:[0,1]
    v_pk_add_f32 v[146:147], v[146:147], v[154:155] neg_lo:[0,1] neg_hi:[0,1]
    v_pk_add_f32 v[148:149], v[148:149], v[156:157] neg_lo:[0,1] neg_hi:[0,1]
    v_pk_add_f32 v[150:151], v[150:151], v[158:159] neg_lo:[0,1] neg_hi:[0,1]
    v_pk_fma_f32 v[80:81], v[200:201], v[144:145], v[104:105] neg_lo:[1,0,0] neg_hi:[1,0,0]
    v_pk_fma_f32 v[84:85], v[200:201], v[148:149], v[108:109] neg_lo:[1,0,0] neg_hi:[1,0,0]
    v_pk_fma_f32 v[88:89], v[200:201], v[144:145], v[104:105]
    v_pk_fma_f32 v[92:93], v[200:201], v[148:149], v[108:109]
    v_pk_mul_f32 v[96:97], v[204:205], v[144:145]
    v_pk_mul_f32 v[100:101], v[204:205], v[148:149]
    v_pk_fma_f32 v[82:83], v[202:203], v[146:147], v[106:107] neg_lo:[1,0,0] neg_hi:[1,0,0]
    v_pk_fma_f32 v[86:87], v[202:203], v[150:151], v[110:111] neg_lo:[1,0,0] neg_hi:[1,0,0]
    v_pk_fma_f32 v[90:91], v[202:203], v[146:147], v[106:107]
    v_pk_fma_f32 v[94:95], v[202:203], v[150:151], v[110:111]
    v_pk_mul_f32 v[98:99], v[206:207], v[146:147]
    v_pk_mul_f32 v[102:103], v[206:207], v[150:151]
    s_cmp_eq_u32 s14, 0
    s_cbranch_scc1 cde_sp2
    v_pk_mul_f32 v[128:129], v[80:81], v[112:113]
    v_pk_mul_f32 v[132:133], v[80:81], v[116:117]
    v_pk_mul_f32 v[136:137], v[88:89], v[120:121]
    v_pk_mul_f32 v[140:141], v[88:89], v[124:125]
    v_pk_mul_f32 v[130:131], v[82:83], v[114:115]
    v_pk_mul_f32 v[134:135], v[82:83], v[118:119]
    v_pk_mul_f32 v[138:139], v[90:91], v[122:123]
    v_pk_mul_f32 v[142:143], v[90:91], v[126:127]
    v_pk_fma_f32 v[128:129], v[84:85], v[116:117], v[128:129] neg_lo:[1,0,0] neg_hi:[1,0,0]
    v_pk_fma_f32 v[132:133], v[84:85], v[112:113], v[132:133]
    v_pk_fma_f32 v[136:137], v[92:93], v[124:125], v[136:137] neg_lo:[1,0,0] neg_hi:[1,0,0]
    v_pk_fma_f32 v[140:141], v[92:93], v[120:121], v[140:141]
    v_pk_fma_f32 v[130:131], v[86:87], v[118:119], v[130:131] neg_lo:[1,0,0] neg_hi:[1,0,0]
    v_pk_fma_f32 v[134:135], v[86:87], v[114:115], v[134:135]
    v_pk_fma_f32 v[138:139], v[94:95], v[126:127], v[138:139] neg_lo:[1,0,0] neg_hi:[1,0,0]
    v_pk_fma_f32 v[142:143], v[94:95], v[122:123], v[142:143]
    v_pk_fma_f32 v[128:129], v[100:101], v[120:121], v[128:129] neg_lo:[1,0,0] neg_hi:[1,0,0]
    v_pk_fma_f32 v[132:133], v[100:101], v[124:125], v[132:133] neg_lo:[1,0,0] neg_hi:[1,0,0]
    v_pk_fma_f32 v[130:131], v[102:103], v[122:123], v[130:131] neg_lo:[1,0,0] neg_hi:[1,0,0]
    v_pk_fma_f32 v[134:135], v[102:103], v[126:127], v[134:135] neg_lo:[1,0,0] neg_hi:[1,0,0]
    v_pk_fma_f32 v[128:129], v[96:97], v[124:125], v[128:129] neg_lo:[1,0,0] neg_hi:[1,0,0]
    v_pk_fma_f32 v[132:133], v[96:97], v[120:121], v[132:133]
    v_pk_fma_f32 v[130:131], v[98:99], v[126:127], v[130:131] neg_lo:[1,0,0] neg_hi:[1,0,0]
    v_pk_fma_f32 v[134:135], v[98:99], v[122:123], v[134:135]
    v_cvt_pk_bf16_f32 v24, v132, v128
    v_cvt_pk_bf16_f32 v25, v133, v129
    v_cvt_pk_bf16_f32 v26, v134, v130
    v_cvt_pk_bf16_f32 v27, v135, v131
    v_pk_fma_f32 v[136:137], v[100:101], v[112:113], v[136:137]
    v_pk_fma_f32 v[140:141], v[100:101], v[116:117], v[140:141]
    v_pk_fma_f32 v[138:139], v[102:103], v[114:115], v[138:139]
    v_pk_fma_f32 v[142:143], v[102:103], v[118:119], v[142:143]
    v_pk_fma_f32 v[136:137], v[96:97], v[116:117], v[136:137]
    v_pk_fma_f32 v[140:141], v[96:97], v[112:113], v[140:141] neg_lo:[1,0,0] neg_hi:[1,0,0]
    v_pk_fma_f32 v[138:139], v[98:99], v[118:119], v[138:139]
    v_pk_fma_f32 v[142:143], v[98:99], v[114:115], v[142:143] neg_lo:[1,0,0] neg_hi:[1,0,0]
cde_sp2r:
    v_mfma_f32_16x16x32_bf16 v[116:119], v[24:27], v[168:171], 0
    v_mfma_f32_16x16x32_bf16 v[112:115], v[24:27], v[172:175], 0
    v_cvt_pk_bf16_f32 v28, v140, v136
    v_cvt_pk_bf16_f32 v29, v141, v137
    v_cvt_pk_bf16_f32 v30, v142, v138
    v_cvt_pk_bf16_f32 v31, v143, v139
    s_nop 1
    v_mfma_f32_16x16x32_bf16 v[124:127], v[28:31], v[168:171], 0
    v_mfma_f32_16x16x32_bf16 v[120:123], v[28:31], v[172:175], 0
    v_pk_mul_f32 v[128:129], v[112:113], v[192:193]
    v_pk_mul_f32 v[130:131], v[114:115], v[194:195]
    v_pk_mul_f32 v[132:133], v[116:117], v[192:193]
    v_pk_mul_f32 v[134:135], v[118:119], v[194:195]
    v_pk_fma_f32 v[128:129], v[116:117], v[196:197], v[128:129] neg_lo:[1,0,0] neg_hi:[1,0,0]
    v_pk_fma_f32 v[130:131], v[118:119], v[198:199], v[130:131] neg_lo:[1,0,0] neg_hi:[1,0,0]
    v_pk_fma_f32 v[132:133], v[112:113], v[196:197], v[132:133]
    v_pk_fma_f32 v[134:135], v[114:115], v[198:199], v[134:135]
    v_cvt_pk_bf16_f32 v24, v128, v132
    v_cvt_pk_bf16_f32 v25, v129, v133
    v_cvt_pk_bf16_f32 v26, v130, v134
    v_cvt_pk_bf16_f32 v27, v131, v135
    s_nop 1
    v_mfma_f32_16x16x32_bf16 v[112:115], v[176:179], v[24:27], 0
    v_mfma_f32_16x16x32_bf16 v[116:119], v[180:183], v[24:27], 0
    v_pk_mul_f32 v[136:137], v[120:121], v[192:193]
    v_pk_mul_f32 v[138:139], v[122:123], v[194:195]
    v_pk_mul_f32 v[140:141], v[124:125], v[192:193]
    v_pk_mul_f32 v[142:143], v[126:127], v[194:195]
    v_pk_fma_f32 v[136:137], v[124:125], v[196:197], v[136:137] neg_lo:[1,0,0] neg_hi:[1,0,0]
    v_pk_fma_f32 v[138:139], v[126:127], v[198:199], v[138:139] neg_lo:[1,0,0] neg_hi:[1,0,0]
    v_pk_fma_f32 v[140:141], v[120:121], v[196:197], v[140:141]
    v_pk_fma_f32 v[142:143], v[122:123], v[198:199], v[142:143]
    v_cvt_pk_bf16_f32 v28, v136, v140
    v_cvt_pk_bf16_f32 v29, v137, v141
    v_cvt_pk_bf16_f32 v30, v138, v142
    v_cvt_pk_bf16_f32 v31, v139, v143
    s_nop 1
    v_mfma_f32_16x16x32_bf16 v[120:123], v[176:179], v[28:31], 0
    v_mfma_f32_16x16x32_bf16 v[124:127], v[180:183], v[28:31], 0
    v_cvt_pk_bf16_f32 v16, v112, v116
    v_cvt_pk_bf16_f32 v17, v113, v117
    v_cvt_pk_bf16_f32 v18, v114, v118
    v_cvt_pk_bf16_f32 v19, v115, v119
    ds_write_b128 v10, v[16:19] offset:8192
    s_nop 2
    v_cvt_pk_bf16_f32 v20, v120, v124
    v_cvt_pk_bf16_f32 v21, v121, v125
    v_cvt_pk_bf16_f32 v22, v122, v126
    v_cvt_pk_bf16_f32 v23, v123, v127
    ds_write_b128 v10, v[20:23] offset:12288
    s_mov_b64 exec, 1
    ds_add_u32 v224, v11 offset:4
    s_mov_b64 exec, -1
cde_b2:
    ds_read_b32 v222, v224 offset:4
    ds_read_b32 v24, v13 offset:8192
    ds_read_b32 v25, v13 offset:9216
    ds_read_b32 v26, v13 offset:10240
    ds_read_b32 v27, v13 offset:11264
    ds_read_b32 v28, v13 offset:8704
    ds_read_b32 v29, v13 offset:9728
    ds_read_b32 v30, v13 offset:10752
    ds_read_b32 v31, v13 offset:11776
    s_waitcnt lgkmcnt(8)
    v_readfirstlane_b32 s15, v222
    s_nop 0
    s_cmp_ge_u32 s15, 4
    s_cbranch_scc0 cde_b2
    s_waitcnt lgkmcnt(4)
    global_store_dwordx4 v4, v[24:27], s[26:27] sc1
    s_waitcnt lgkmcnt(0)
    global_store_dwordx4 v12, v[28:31], s[26:27] sc1
    s_nop 1
    v_mov_b32 v28, 110592
    s_branch cde_A
cde_sp1:
    v_and_b32 v14, 15, v1
    v_lshrrev_b32 v15, 4, v1
    v_lshl_add_u32 v14, v15, 6, v14
    v_cmp_ne_u32 vcc, 0, v2
    s_nop 1
    v_addc_co_u32 v14, vcc, 0, v14, vcc
    v_sub_u32 v15, 0, v2
    v_and_b32 v15, 3, v15
    v_lshlrev_b32 v15, 10, v15
    v_add_u32 v15, 131072, v15
    v_add_u32 v16, 0, v14
    v_sub_u32 v16, 0, v16
    v_and_b32 v16, 255, v16
    v_and_b32 v17, 15, v16
    v_lshrrev_b32 v18, 6, v16
    v_lshl_add_u32 v17, v18, 4, v17
    v_bfe_u32 v18, v16, 4, 2
    v_lshl_add_u32 v17, v18, 6, v17
    v_lshl_add_u32 v72, v17, 2, v15
    v_add_u32 v16, 16, v14
    v_sub_u32 v16, 0, v16
    v_and_b32 v16, 255, v16
    v_and_b32 v17, 15, v16
    v_lshrrev_b32 v18, 6, v16
    v_lshl_add_u32 v17, v18, 4, v17
    v_bfe_u32 v18, v16, 4, 2
    v_lshl_add_u32 v17, v18, 6, v17
    v_lshl_add_u32 v73, v17, 2, v15
    v_add_u32 v16, 32, v14
    v_sub_u32 v16, 0, v16
    v_and_b32 v16, 255, v16
    v_and_b32 v17, 15, v16
    v_lshrrev_b32 v18, 6, v16
    v_lshl_add_u32 v17, v18, 4, v17
    v_bfe_u32 v18, v16, 4, 2
    v_lshl_add_u32 v17, v18, 6, v17
    v_lshl_add_u32 v74, v17, 2, v15
    v_add_u32 v16, 48, v14
    v_sub_u32 v16, 0, v16
    v_and_b32 v16, 255, v16
    v_and_b32 v17, 15, v16
    v_lshrrev_b32 v18, 6, v16
    v_lshl_add_u32 v17, v18, 4, v17
    v_bfe_u32 v18, v16, 4, 2
    v_lshl_add_u32 v17, v18, 6, v17
    v_lshl_add_u32 v75, v17, 2, v15
    v_lshlrev_b32 v76, 2, v1
    v_lshl_add_u32 v76, v2, 10, v76
    v_add_u32 v76, 131072, v76
    s_branch cde_sp1r
cde_sp2:
    ds_write2st64_b32 v76, v112, v113 offset0:0 offset1:1
    ds_write2st64_b32 v76, v114, v115 offset0:2 offset1:3
    ds_write2st64_b32 v76, v116, v117 offset0:16 offset1:17
    ds_write2st64_b32 v76, v118, v119 offset0:18 offset1:19
    ds_write2st64_b32 v76, v120, v121 offset0:32 offset1:33
    ds_write2st64_b32 v76, v122, v123 offset0:34 offset1:35
    ds_write2st64_b32 v76, v124, v125 offset0:48 offset1:49
    ds_write2st64_b32 v76, v126, v127 offset0:50 offset1:51
    s_mov_b64 exec, 1
    ds_add_u32 v224, v11 offset:36
    s_mov_b64 exec, -1
    v_lshlrev_b32 v144, 16, v40
    v_and_b32 v148, 0xffff0000, v40
    v_lshlrev_b32 v152, 16, v41
    v_and_b32 v156, 0xffff0000, v41
    v_lshlrev_b32 v145, 16, v42
    v_and_b32 v149, 0xffff0000, v42
    v_lshlrev_b32 v153, 16, v43
    v_and_b32 v157, 0xffff0000, v43
    v_lshlrev_b32 v146, 16, v44
    v_and_b32 v150, 0xffff0000, v44
    v_lshlrev_b32 v154, 16, v45
    v_and_b32 v158, 0xffff0000, v45
    v_lshlrev_b32 v147, 16, v46
    v_and_b32 v151, 0xffff0000, v46
    v_lshlrev_b32 v155, 16, v47
    v_and_b32 v159, 0xffff0000, v47
    v_pk_add_f32 v[104:105], v[144:145], v[152:153]
    v_pk_add_f32 v[106:107], v[146:147], v[154:155]
    v_pk_add_f32 v[108:109], v[148:149], v[156:157]
    v_pk_add_f32 v[110:111], v[150:151], v[158:159]
    v_pk_add_f32 v[144:145], v[144:145], v[152:153] neg_lo:[0,1] neg_hi:[0,1]
    v_pk_add_f32 v[146:147], v[146:147], v[154:155] neg_lo:[0,1] neg_hi:[0,1]
    v_pk_add_f32 v[148:149], v[148:149], v[156:157] neg_lo:[0,1] neg_hi:[0,1]
    v_pk_add_f32 v[150:151], v[150:151], v[158:159] neg_lo:[0,1] neg_hi:[0,1]
    v_pk_fma_f32 v[88:89], v[200:201], v[144:145], v[104:105]
    v_pk_fma_f32 v[92:93], v[200:201], v[148:149], v[108:109]
    v_pk_mul_f32 v[48:49], v[204:205], v[144:145]
    v_pk_mul_f32 v[52:53], v[204:205], v[148:149]
    v_pk_fma_f32 v[90:91], v[202:203], v[146:147], v[106:107]
    v_pk_fma_f32 v[94:95], v[202:203], v[150:151], v[110:111]
    v_pk_mul_f32 v[50:51], v[206:207], v[146:147]
    v_pk_mul_f32 v[54:55], v[206:207], v[150:151]
    v_pk_mul_f32 v[128:129], v[80:81], v[112:113]
    v_pk_mul_f32 v[132:133], v[80:81], v[116:117]
    v_pk_mul_f32 v[136:137], v[88:89], v[120:121]
    v_pk_mul_f32 v[140:141], v[88:89], v[124:125]
    v_pk_mul_f32 v[130:131], v[82:83], v[114:115]
    v_pk_mul_f32 v[134:135], v[82:83], v[118:119]
    v_pk_mul_f32 v[138:139], v[90:91], v[122:123]
    v_pk_mul_f32 v[142:143], v[90:91], v[126:127]
    v_pk_fma_f32 v[128:129], v[84:85], v[116:117], v[128:129] neg_lo:[1,0,0] neg_hi:[1,0,0]
    v_pk_fma_f32 v[132:133], v[84:85], v[112:113], v[132:133]
    v_pk_fma_f32 v[136:137], v[92:93], v[124:125], v[136:137] neg_lo:[1,0,0] neg_hi:[1,0,0]
    v_pk_fma_f32 v[140:141], v[92:93], v[120:121], v[140:141]
    v_pk_fma_f32 v[130:131], v[86:87], v[118:119], v[130:131] neg_lo:[1,0,0] neg_hi:[1,0,0]
    v_pk_fma_f32 v[134:135], v[86:87], v[114:115], v[134:135]
    v_pk_fma_f32 v[138:139], v[94:95], v[126:127], v[138:139] neg_lo:[1,0,0] neg_hi:[1,0,0]
    v_pk_fma_f32 v[142:143], v[94:95], v[122:123], v[142:143]
cde_lw5:
    ds_read_b32 v222, v224 offset:36
    s_waitcnt lgkmcnt(0)
    v_readfirstlane_b32 s15, v222
    s_nop 0
    s_cmp_ge_u32 s15, 4
    s_cbranch_scc0 cde_lw5
    ds_read2st64_b32 v[236:237], v72 offset0:0 offset1:16
    ds_read2st64_b32 v[238:239], v73 offset0:0 offset1:16
    ds_read2st64_b32 v[240:241], v74 offset0:0 offset1:16
    ds_read2st64_b32 v[242:243], v75 offset0:0 offset1:16
    ds_read2st64_b32 v[244:245], v72 offset0:32 offset1:48
    ds_read2st64_b32 v[246:247], v73 offset0:32 offset1:48
    ds_read2st64_b32 v[248:249], v74 offset0:32 offset1:48
    ds_read2st64_b32 v[250:251], v75 offset0:32 offset1:48
    s_waitcnt lgkmcnt(4)
    v_mov_b32 v56, v236
    v_mov_b32 v60, v237
    v_mov_b32 v57, v238
    v_mov_b32 v61, v239
    v_mov_b32 v58, v240
    v_mov_b32 v62, v241
    v_mov_b32 v59, v242
    v_mov_b32 v63, v243
    s_waitcnt lgkmcnt(0)
    v_mov_b32 v64, v244
    v_mov_b32 v68, v245
    v_mov_b32 v65, v246
    v_mov_b32 v69, v247
    v_mov_b32 v66, v248
    v_mov_b32 v70, v249
    v_mov_b32 v67, v250
    v_mov_b32 v71, v251
    v_pk_fma_f32 v[128:129], v[100:101], v[56:57], v[128:129] neg_lo:[1,0,0] neg_hi:[1,0,0]
    v_pk_fma_f32 v[132:133], v[100:101], v[60:61], v[132:133]
    v_pk_fma_f32 v[130:131], v[102:103], v[58:59], v[130:131] neg_lo:[1,0,0] neg_hi:[1,0,0]
    v_pk_fma_f32 v[134:135], v[102:103], v[62:63], v[134:135]
    v_pk_fma_f32 v[128:129], v[96:97], v[60:61], v[128:129]
    v_pk_fma_f32 v[132:133], v[96:97], v[56:57], v[132:133]
    v_pk_fma_f32 v[130:131], v[98:99], v[62:63], v[130:131]
    v_pk_fma_f32 v[134:135], v[98:99], v[58:59], v[134:135]
    v_cvt_pk_bf16_f32 v24, v132, v128
    v_cvt_pk_bf16_f32 v25, v133, v129
    v_cvt_pk_bf16_f32 v26, v134, v130
    v_cvt_pk_bf16_f32 v27, v135, v131
    v_pk_fma_f32 v[136:137], v[52:53], v[64:65], v[136:137]
    v_pk_fma_f32 v[140:141], v[52:53], v[68:69], v[140:141] neg_lo:[1,0,0] neg_hi:[1,0,0]
    v_pk_fma_f32 v[138:139], v[54:55], v[66:67], v[138:139]
    v_pk_fma_f32 v[142:143], v[54:55], v[70:71], v[142:143] neg_lo:[1,0,0] neg_hi:[1,0,0]
    v_pk_fma_f32 v[136:137], v[48:49], v[68:69], v[136:137] neg_lo:[1,0,0] neg_hi:[1,0,0]
    v_pk_fma_f32 v[140:141], v[48:49], v[64:65], v[140:141] neg_lo:[1,0,0] neg_hi:[1,0,0]
    v_pk_fma_f32 v[138:139], v[50:51], v[70:71], v[138:139] neg_lo:[1,0,0] neg_hi:[1,0,0]
    v_pk_fma_f32 v[142:143], v[50:51], v[66:67], v[142:143] neg_lo:[1,0,0] neg_hi:[1,0,0]
    s_branch cde_sp2r
cde_L:
    v_and_b32 v4, 255, v0
    s_and_b32 s22, s23, 3
    s_memrealtime s[60:61]
    v_lshlrev_b32 v5, 1, v1
    v_mul_u32_u24 v6, 6144, v1
    s_lshl_b32 s10, s14, 3
    v_add_u32 v7, s10, v6
    s_cmp_lt_u32 s22, 2
    s_cbranch_scc0 cde_clp
    s_waitcnt lgkmcnt(0)
    s_or_b32 s57, s14, s22
    s_cmp_eq_u32 s57, 0
    s_cbranch_scc0 cde_nn
    s_or_b32 s60, s60, 1
    v_mov_b32 v46, s60
    v_mov_b32 v47, 0
    s_mov_b64 exec, 1
    global_store_dword v47, v46, s[62:63] sc1
    s_mov_b64 exec, -1
cde_nn:
    global_load_ushort v104, v5, s[40:41] offset:0
    global_load_ushort v105, v5, s[40:41] offset:128
    global_load_ushort v106, v5, s[40:41] offset:256
    global_load_ushort v107, v5, s[40:41] offset:384
    global_load_ushort v108, v5, s[40:41] offset:512
    global_load_ushort v109, v5, s[40:41] offset:640
    global_load_ushort v110, v5, s[40:41] offset:768
    global_load_ushort v111, v5, s[40:41] offset:896
    s_cmp_eq_u32 s22, 0
    s_cbranch_scc0 cde_nm0
    global_load_dwordx2 v[112:113], v7, s[42:43]
    v_add_u32 v7, 393216, v7
    global_load_dwordx2 v[114:115], v7, s[42:43]
    v_add_u32 v7, 393216, v7
    global_load_dwordx2 v[116:117], v7, s[42:43]
    v_add_u32 v7, 393216, v7
    global_load_dwordx2 v[118:119], v7, s[42:43]
    v_add_u32 v7, 393216, v7
    global_load_dwordx2 v[120:121], v7, s[42:43]
    v_add_u32 v7, 393216, v7
    global_load_dwordx2 v[122:123], v7, s[42:43]
    v_add_u32 v7, 393216, v7
    global_load_dwordx2 v[124:125], v7, s[42:43]
    v_add_u32 v7, 393216, v7
    global_load_dwordx2 v[126:127], v7, s[42:43]
    s_branch cde_nm0
cde_clp:
    s_lshl_b32 s10, s14, 13
    s_lshl_b32 s57, s22, 12
    s_add_u32 s10, s10, s57
    s_add_u32 s10, s10, 4186112
    v_add_u32 v7, s10, v3
    v_mov_b32 v100, -1
    v_mov_b32 v101, -1
    v_mov_b32 v102, -1
    v_mov_b32 v103, -1
    s_waitcnt lgkmcnt(0)
    s_sub_u32 s57, s22, 1
    s_lshr_b32 s10, s14, 5
    s_and_b32 s11, s14, 31
    s_mul_i32 s11, s11, 98304
    s_add_u32 s12, s57, 7
    s_lshl_b32 s10, s10, s12
    s_add_u32 s10, s10, s11
    s_cmp_eq_u32 s22, 3
    s_cselect_b32 s11, 2048, 0
    s_cselect_b32 s12, 3, 1
    s_add_u32 s10, s10, s11
    v_lshrrev_b32 v8, s57, v1
    v_and_b32 v8, 15, v8
    v_mul_u32_u24 v8, 6144, v8
    v_and_b32 v9, s12, v1
    v_lshl_add_u32 v8, v9, 7, v8
    v_add_u32 v8, s10, v8
    global_load_dword v38, v8, s[42:43]
    global_store_dwordx4 v7, v[100:103], s[8:9] offset:0 sc1
    global_store_dwordx4 v7, v[100:103], s[8:9] offset:1024 sc1
    global_store_dwordx4 v7, v[100:103], s[8:9] offset:2048 sc1
    global_store_dwordx4 v7, v[100:103], s[8:9] offset:3072 sc1
cde_nm0:
    s_barrier
    s_sleep 2
    v_mov_b32 v222, 0
    global_load_dword v223, v222, s[62:63] sc1
    s_bfe_u32 s11, s2, 0x20003
    s_lshr_b32 s12, s2, 5
    s_lshl_b32 s12, s12, 3
    s_and_b32 s13, s2, 7
    s_add_u32 s12, s12, s13
    s_lshl_b32 s10, s14, 4
    s_add_u32 s10, s10, 2048
    v_add_u32 v221, s10, v6
    s_and_b32 s16, s12, 3
    s_lshl_b32 s16, s16, 2
    s_add_u32 s17, s16, s22
    s_bfe_u32 s18, s12, 0x20002
    s_lshr_b32 s19, s12, 4
    s_lshl_b32 s17, s17, 2
    s_add_u32 s17, s17, s18
    s_lshl_b32 s20, s19, 8
    s_add_u32 s17, s17, s20
    s_mul_i32 s17, s17, 514
    s_lshl_b32 s20, s11, 7
    s_add_u32 s17, s17, s20
    v_lshl_add_u32 v12, v1, 1, s17
    s_cmp_lt_u32 s2, 128
    s_cselect_b32 s68, s22, 0
    s_cmp_eq_u32 s68, 3
    s_cselect_b32 s68, 1, 0
    s_cbranch_scc0 cde_ns1
    s_bfe_u32 s20, s2, 0x20004
    s_and_b32 s21, s2, 3
    s_lshl_b32 s21, s21, 4
    s_add_u32 s20, s20, s21
    s_bfe_u32 s21, s2, 0x20002
    s_lshl_b32 s21, s21, 8
    s_add_u32 s20, s20, s21
    v_and_b32 v21, 12, v1
    v_and_b32 v22, 3, v1
    v_lshl_add_u32 v21, v22, 6, v21
    v_add_u32 v21, s20, v21
    v_add_u32 v22, 1024, v21
    v_sub_u32 v23, 2048, v21
    v_and_b32 v23, 2047, v23
    v_sub_u32 v24, 1024, v21
    v_and_b32 v24, 2047, v24
    s_movk_i32 s20, 514
    s_lshr_b32 s21, s2, 6
    s_lshl_b32 s21, s21, 9
    v_mov_b32 v25, s21
    v_mad_u32_u24 v32, v21, s20, v25
    v_mad_u32_u24 v33, v22, s20, v25
    v_mad_u32_u24 v34, v23, s20, v25
    v_mad_u32_u24 v35, v24, s20, v25
    s_mov_b64 exec, 0xffff
    global_load_ushort v80, v32, s[44:45]
    global_load_ushort v84, v32, s[46:47]
    global_load_ushort v81, v33, s[44:45]
    global_load_ushort v85, v33, s[46:47]
    global_load_ushort v82, v34, s[44:45]
    global_load_ushort v86, v34, s[46:47]
    global_load_ushort v83, v35, s[44:45]
    global_load_ushort v87, v35, s[46:47]
    s_mov_b64 exec, -1
cde_ns1:
    global_load_ushort v64, v12, s[44:45]
    global_load_ushort v72, v12, s[46:47]
    v_add_u32 v13, 526336, v12
    global_load_ushort v65, v13, s[44:45]
    global_load_ushort v73, v13, s[46:47]
    v_add_u32 v13, 32896, v12
    global_load_ushort v66, v13, s[44:45]
    global_load_ushort v74, v13, s[46:47]
    v_add_u32 v13, 559232, v12
    global_load_ushort v67, v13, s[44:45]
    global_load_ushort v75, v13, s[46:47]
    v_add_u32 v13, 65792, v12
    global_load_ushort v68, v13, s[44:45]
    global_load_ushort v76, v13, s[46:47]
    v_add_u32 v13, 592128, v12
    global_load_ushort v69, v13, s[44:45]
    global_load_ushort v77, v13, s[46:47]
    v_add_u32 v13, 98688, v12
    global_load_ushort v70, v13, s[44:45]
    global_load_ushort v78, v13, s[46:47]
    v_add_u32 v13, 625024, v12
    global_load_ushort v71, v13, s[44:45]
    global_load_ushort v79, v13, s[46:47]
    s_cmp_lt_u32 s22, 2
    s_cbranch_scc0 cde_t2
    global_load_dword v39, v222, s[62:63]
    s_branch cde_t3
cde_t2:
    s_cmp_eq_u32 s22, 2
    s_cselect_b32 s24, s52, s54
    s_cselect_b32 s25, s53, s55
    s_mul_i32 s57, s2, 5504
    v_min_u32 v48, 42, v1
    v_lshlrev_b32 v48, 7, v48
    v_add_u32 v48, s57, v48
    global_load_dword v39, v48, s[24:25]
cde_t3:
    s_mov_b32 s20, 0x05040100
    s_mov_b32 s21, 0x07060302
    s_cmp_lt_u32 s22, 2
    s_cbranch_scc1 cde_c1
    s_waitcnt vmcnt(18)
    s_mov_b64 exec, 1
    ds_add_u32 v28, v11 offset:44
    s_mov_b64 exec, -1
    s_branch cde_np
cde_c1:
    s_waitcnt vmcnt(26)
    s_cmp_eq_u32 s22, 0
    s_cbranch_scc1 cde_c0
    s_waitcnt vmcnt(18)
cde_c0:
    v_lshlrev_b32 v104, 16, v104
    v_lshlrev_b32 v105, 16, v105
    v_lshlrev_b32 v106, 16, v106
    v_lshlrev_b32 v107, 16, v107
    v_lshlrev_b32 v108, 16, v108
    v_lshlrev_b32 v109, 16, v109
    v_lshlrev_b32 v110, 16, v110
    v_lshlrev_b32 v111, 16, v111
    v_mul_f32 v200, 0xbfb8aa3b, v104
    v_mul_f32 v201, 0xbfb8aa3b, v105
    v_mul_f32 v202, 0xbfb8aa3b, v106
    v_mul_f32 v203, 0xbfb8aa3b, v107
    v_mul_f32 v204, 0xbfb8aa3b, v108
    v_mul_f32 v205, 0xbfb8aa3b, v109
    v_mul_f32 v206, 0xbfb8aa3b, v110
    v_mul_f32 v207, 0xbfb8aa3b, v111
    v_exp_f32 v200, v200
    v_exp_f32 v201, v201
    v_exp_f32 v202, v202
    v_exp_f32 v203, v203
    v_exp_f32 v204, v204
    v_exp_f32 v205, v205
    v_exp_f32 v206, v206
    v_exp_f32 v207, v207
    v_add_f32 v200, 1.0, v200
    v_add_f32 v201, 1.0, v201
    v_add_f32 v202, 1.0, v202
    v_add_f32 v203, 1.0, v203
    v_add_f32 v204, 1.0, v204
    v_add_f32 v205, 1.0, v205
    v_add_f32 v206, 1.0, v206
    v_add_f32 v207, 1.0, v207
    v_rcp_f32 v200, v200
    v_rcp_f32 v201, v201
    v_rcp_f32 v202, v202
    v_rcp_f32 v203, v203
    v_rcp_f32 v204, v204
    v_rcp_f32 v205, v205
    v_rcp_f32 v206, v206
    v_rcp_f32 v207, v207
    v_mul_f32 v104, v104, v200
    v_mul_f32 v105, v105, v201
    v_mul_f32 v106, v106, v202
    v_mul_f32 v107, v107, v203
    v_mul_f32 v108, v108, v204
    v_mul_f32 v109, v109, v205
    v_mul_f32 v110, v110, v206
    v_mul_f32 v111, v111, v207
    v_cvt_pk_bf16_f32 v216, v104, v105
    v_cvt_pk_bf16_f32 v217, v106, v107
    v_cvt_pk_bf16_f32 v218, v108, v109
    v_cvt_pk_bf16_f32 v219, v110, v111
    s_cmp_eq_u32 s22, 0
    s_cbranch_scc0 cde_np
    s_lshl_b32 s57, s14, 7
    s_add_u32 s57, s57, 64640
    v_add_u32 v41, s57, v3
    s_cmp_ge_u32 s14, 128
    s_cselect_b32 s10, 1.0, 0
    s_waitcnt vmcnt(18)
    v_perm_b32 v200, v114, v112, s20
    v_perm_b32 v201, v114, v112, s21
    v_perm_b32 v202, v115, v113, s20
    v_perm_b32 v203, v115, v113, s21
    v_dot2_f32_bf16 v96, v200, v216, 0
    v_dot2_f32_bf16 v97, v201, v216, 0
    v_dot2_f32_bf16 v98, v202, v216, 0
    v_dot2_f32_bf16 v99, v203, v216, 0
    v_perm_b32 v200, v118, v116, s20
    v_perm_b32 v201, v118, v116, s21
    v_perm_b32 v202, v119, v117, s20
    v_perm_b32 v203, v119, v117, s21
    v_dot2_f32_bf16 v96, v200, v217, v96
    v_dot2_f32_bf16 v97, v201, v217, v97
    v_dot2_f32_bf16 v98, v202, v217, v98
    v_dot2_f32_bf16 v99, v203, v217, v99
    v_perm_b32 v200, v122, v120, s20
    v_perm_b32 v201, v122, v120, s21
    v_perm_b32 v202, v123, v121, s20
    v_perm_b32 v203, v123, v121, s21
    v_dot2_f32_bf16 v96, v200, v218, v96
    v_dot2_f32_bf16 v97, v201, v218, v97
    v_dot2_f32_bf16 v98, v202, v218, v98
    v_dot2_f32_bf16 v99, v203, v218, v99
    v_perm_b32 v200, v126, v124, s20
    v_perm_b32 v201, v126, v124, s21
    v_perm_b32 v202, v127, v125, s20
    v_perm_b32 v203, v127, v125, s21
    v_dot2_f32_bf16 v96, v200, v219, v96
    v_dot2_f32_bf16 v97, v201, v219, v97
    v_dot2_f32_bf16 v98, v202, v219, v98
    v_dot2_f32_bf16 v99, v203, v219, v99
    s_nop 2
    v_add_f32_dpp v96, v96, v96 row_ror:8 row_mask:0xf bank_mask:0xf
    v_add_f32_dpp v97, v97, v97 row_ror:8 row_mask:0xf bank_mask:0xf
    v_add_f32_dpp v98, v98, v98 row_ror:8 row_mask:0xf bank_mask:0xf
    v_add_f32_dpp v99, v99, v99 row_ror:8 row_mask:0xf bank_mask:0xf
    v_add_f32_dpp v96, v96, v96 row_ror:4 row_mask:0xf bank_mask:0xf
    v_add_f32_dpp v97, v97, v97 row_ror:4 row_mask:0xf bank_mask:0xf
    v_add_f32_dpp v98, v98, v98 row_ror:4 row_mask:0xf bank_mask:0xf
    v_add_f32_dpp v99, v99, v99 row_ror:4 row_mask:0xf bank_mask:0xf
    v_add_f32_dpp v96, v96, v96 row_ror:2 row_mask:0xf bank_mask:0xf
    v_add_f32_dpp v97, v97, v97 row_ror:2 row_mask:0xf bank_mask:0xf
    v_add_f32_dpp v98, v98, v98 row_ror:2 row_mask:0xf bank_mask:0xf
    v_add_f32_dpp v99, v99, v99 row_ror:2 row_mask:0xf bank_mask:0xf
    v_add_f32_dpp v96, v96, v96 row_ror:1 row_mask:0xf bank_mask:0xf
    v_add_f32_dpp v97, v97, v97 row_ror:1 row_mask:0xf bank_mask:0xf
    v_add_f32_dpp v98, v98, v98 row_ror:1 row_mask:0xf bank_mask:0xf
    v_add_f32_dpp v99, v99, v99 row_ror:1 row_mask:0xf bank_mask:0xf
    v_add_f32_dpp v96, v96, v96 row_bcast:15 row_mask:0xa bank_mask:0xf
    v_add_f32_dpp v97, v97, v97 row_bcast:15 row_mask:0xa bank_mask:0xf
    v_add_f32_dpp v98, v98, v98 row_bcast:15 row_mask:0xa bank_mask:0xf
    v_add_f32_dpp v99, v99, v99 row_bcast:15 row_mask:0xa bank_mask:0xf
    v_add_f32_dpp v96, v96, v96 row_bcast:31 row_mask:0xc bank_mask:0xf
    v_add_f32_dpp v97, v97, v97 row_bcast:31 row_mask:0xc bank_mask:0xf
    v_add_f32_dpp v98, v98, v98 row_bcast:31 row_mask:0xc bank_mask:0xf
    v_add_f32_dpp v99, v99, v99 row_bcast:31 row_mask:0xc bank_mask:0xf
    v_cvt_pk_bf16_f32 v100, v96, v97
    v_cvt_pk_bf16_f32 v101, v98, v99
    v_lshlrev_b32 v96, 16, v100
    v_and_b32 v97, 0xffff0000, v100
    v_lshlrev_b32 v98, 16, v101
    v_and_b32 v99, 0xffff0000, v101
    v_add_f32 v96, s10, v96
    v_add_f32 v97, s10, v97
    v_add_f32 v98, s10, v98
    v_add_f32 v99, s10, v99
    v_cvt_pk_bf16_f32 v100, v96, v97
    v_cvt_pk_bf16_f32 v101, v98, v99
    s_movk_i32 s57, 0x7fff
    s_waitcnt vmcnt(17)
cde_n:
    v_readfirstlane_b32 s64, v223
    s_nop 0
    s_cmp_lg_u32 s64, 0
    s_cbranch_scc1 cde_n_ok
    global_load_dword v223, v222, s[62:63] sc1
    s_sub_u32 s57, s57, 1
    s_waitcnt vmcnt(00)
    s_cmp_lg_u32 s57, 0
    s_cbranch_scc1 cde_n
    s_mov_b32 s64, 1
cde_n_ok:
cde_lw6:
    ds_read_b32 v29, v28 offset:44
    s_waitcnt lgkmcnt(0)
    v_readfirstlane_b32 s15, v29
    s_nop 0
    s_cmp_ge_u32 s15, 2
    s_cbranch_scc0 cde_lw6
    v_mov_b32 v103, s64
    v_xor_b32 v102, v100, v101
    v_xor_b32 v102, s64, v102
    s_mov_b32 exec_lo, 0
    s_mov_b32 exec_hi, 0xff000000
    global_store_dwordx4 v41, v[100:103], s[8:9] sc1
    ds_write_b32 v28, v103 offset:204
    s_mov_b64 exec, -1
cde_np:
    v_and_b32 v12, 3, v1
    v_xor_b32 v12, s22, v12
    v_lshlrev_b32 v12, 5, v12
    v_lshl_add_u32 v12, v1, 7, v12
    v_add_u32 v12, 114688, v12
    v_lshrrev_b32 v13, 3, v4
    v_and_b32 v14, 7, v4
    v_and_b32 v15, 3, v13
    v_lshlrev_b32 v15, 1, v15
    v_xor_b32 v15, v14, v15
    v_lshlrev_b32 v15, 4, v15
    v_lshl_add_u32 v15, v13, 7, v15
    v_add_u32 v15, 114688, v15
    s_lshl_b32 s18, s18, 11
    s_lshl_b32 s19, s19, 4
    s_add_u32 s19, s19, s16
    s_lshl_b32 s19, s19, 5
    s_add_u32 s18, s18, s19
    s_lshl_b32 s19, s11, 19
    s_add_u32 s18, s18, s19
    s_add_u32 s18, s18, 1048576
    v_lshlrev_b32 v16, 13, v13
    v_lshl_add_u32 v16, v14, 4, v16
    v_add_u32 v16, s18, v16
    v_add_u32 v17, 0x3e000, v16
    v_add_u32 v18, 0x40000, v17
    v_cmp_eq_u32 vcc, 0, v13
    s_nop 1
    v_cndmask_b32 v17, v17, v18, vcc
    s_lshl_b32 s19, s11, 6
    v_add_u32 v13, s19, v13
    v_cmp_ne_u32 s[12:13], 0, v13
    s_waitcnt vmcnt(1)
    v_lshl_or_b32 v64, v72, 16, v64
    v_lshl_or_b32 v65, v73, 16, v65
    v_lshl_or_b32 v66, v74, 16, v66
    v_lshl_or_b32 v67, v75, 16, v67
    v_lshl_or_b32 v68, v76, 16, v68
    v_lshl_or_b32 v69, v77, 16, v69
    v_lshl_or_b32 v70, v78, 16, v70
    v_lshl_or_b32 v71, v79, 16, v71
    ds_write_b128 v12, v[64:67]
    ds_write_b128 v12, v[68:71] offset:16
    s_mov_b64 exec, 1
    ds_add_u32 v28, v11 offset:40
    s_mov_b64 exec, -1
    s_cmp_eq_u32 s22, 1
    s_cbranch_scc0 cde_mr
cde_lw7:
    ds_read_b32 v29, v28 offset:204
    s_waitcnt lgkmcnt(0)
    v_readfirstlane_b32 s15, v29
    s_nop 0
    s_cmp_ge_u32 s15, 1
    s_cbranch_scc0 cde_lw7
    global_load_dwordx4 v[128:131], v221, s[42:43] offset:0
    v_add_u32 v221, 393216, v221
    global_load_dwordx4 v[132:135], v221, s[42:43] offset:0
    v_add_u32 v221, 393216, v221
    global_load_dwordx4 v[136:139], v221, s[42:43] offset:0
    v_add_u32 v221, 393216, v221
    global_load_dwordx4 v[140:143], v221, s[42:43] offset:0
    v_add_u32 v221, 393216, v221
    global_load_dwordx4 v[144:147], v221, s[42:43] offset:0
    v_add_u32 v221, 393216, v221
    global_load_dwordx4 v[148:151], v221, s[42:43] offset:0
    v_add_u32 v221, 393216, v221
    global_load_dwordx4 v[152:155], v221, s[42:43] offset:0
    v_add_u32 v221, 393216, v221
    global_load_dwordx4 v[156:159], v221, s[42:43] offset:0
cde_mr:
    s_cmp_eq_u32 s68, 1
    s_cbranch_scc0 cde_ns2
    v_lshlrev_b32 v80, 16, v80
    v_lshlrev_b32 v81, 16, v81
    v_lshlrev_b32 v82, 16, v82
    v_lshlrev_b32 v83, 16, v83
    v_lshlrev_b32 v84, 16, v84
    v_lshlrev_b32 v85, 16, v85
    v_lshlrev_b32 v86, 16, v86
    v_lshlrev_b32 v87, 16, v87
    v_add_f32 v80, v80, v82
    v_add_f32 v81, v81, v83
    v_sub_f32 v84, v84, v86
    v_sub_f32 v85, v85, v87
    v_mul_f32 v80, 0.5, v80
    v_mul_f32 v81, 0.5, v81
    v_mul_f32 v84, 0.5, v84
    v_mul_f32 v85, 0.5, v85
    v_cvt_pk_bf16_f32 v82, v80, v84
    v_cvt_pk_bf16_f32 v83, v81, v85
    s_and_b32 s69, s2, 63
    s_lshl_b32 s69, s69, 7
    s_lshr_b32 s57, s2, 6
    s_lshl_b32 s57, s57, 21
    s_add_u32 s69, s69, s57
    s_add_u32 s69, s69, 1048576
    v_lshl_add_u32 v18, v1, 3, s69
    s_mov_b64 exec, 0xffff
    global_store_dwordx2 v18, v[82:83], s[8:9] sc1
    s_mov_b64 exec, -1
cde_ns2:
cde_lw8:
    ds_read_b32 v29, v28 offset:40
    s_waitcnt lgkmcnt(0)
    v_readfirstlane_b32 s15, v29
    s_nop 0
    s_cmp_ge_u32 s15, 4
    s_cbranch_scc0 cde_lw8
    ds_read_b128 v[64:67], v15
    ds_read_b128 v[68:71], v15 offset:4096
    s_waitcnt lgkmcnt(0)
    global_store_dwordx4 v17, v[68:71], s[8:9] sc1
    s_mov_b64 exec, s[12:13]
    global_store_dwordx4 v16, v[64:67], s[8:9] sc1
    s_mov_b64 exec, -1
    s_cmp_eq_u32 s22, 1
    s_cbranch_scc0 cde_nr
    s_lshr_b32 s66, s14, 6
    s_cmp_eq_u32 s66, 2
    s_cselect_b32 s67, 1.0, 0
    s_mov_b32 s69, 0xbfb8aa3b
    s_cmp_eq_u32 s66, 0
    s_cselect_b32 s69, 1.0, s69
    s_cmp_eq_u32 s66, 3
    s_cselect_b32 s69, 0xbf317218, s69
    s_lshl_b32 s57, s14, 5
    s_add_u32 s57, s57, 4096
    v_mov_b32 v41, s57
    s_waitcnt vmcnt(2)
    v_perm_b32 v200, v132, v128, s20
    v_perm_b32 v201, v132, v128, s21
    v_perm_b32 v202, v133, v129, s20
    v_perm_b32 v203, v133, v129, s21
    v_perm_b32 v204, v134, v130, s20
    v_perm_b32 v205, v134, v130, s21
    v_perm_b32 v206, v135, v131, s20
    v_perm_b32 v207, v135, v131, s21
    v_dot2_f32_bf16 v96, v200, v216, 0
    v_dot2_f32_bf16 v97, v201, v216, 0
    v_dot2_f32_bf16 v98, v202, v216, 0
    v_dot2_f32_bf16 v99, v203, v216, 0
    v_dot2_f32_bf16 v100, v204, v216, 0
    v_dot2_f32_bf16 v101, v205, v216, 0
    v_dot2_f32_bf16 v102, v206, v216, 0
    v_dot2_f32_bf16 v103, v207, v216, 0
    v_perm_b32 v200, v140, v136, s20
    v_perm_b32 v201, v140, v136, s21
    v_perm_b32 v202, v141, v137, s20
    v_perm_b32 v203, v141, v137, s21
    v_perm_b32 v204, v142, v138, s20
    v_perm_b32 v205, v142, v138, s21
    v_perm_b32 v206, v143, v139, s20
    v_perm_b32 v207, v143, v139, s21
    v_dot2_f32_bf16 v96, v200, v217, v96
    v_dot2_f32_bf16 v97, v201, v217, v97
    v_dot2_f32_bf16 v98, v202, v217, v98
    v_dot2_f32_bf16 v99, v203, v217, v99
    v_dot2_f32_bf16 v100, v204, v217, v100
    v_dot2_f32_bf16 v101, v205, v217, v101
    v_dot2_f32_bf16 v102, v206, v217, v102
    v_dot2_f32_bf16 v103, v207, v217, v103
    v_perm_b32 v200, v148, v144, s20
    v_perm_b32 v201, v148, v144, s21
    v_perm_b32 v202, v149, v145, s20
    v_perm_b32 v203, v149, v145, s21
    v_perm_b32 v204, v150, v146, s20
    v_perm_b32 v205, v150, v146, s21
    v_perm_b32 v206, v151, v147, s20
    v_perm_b32 v207, v151, v147, s21
    v_dot2_f32_bf16 v96, v200, v218, v96
    v_dot2_f32_bf16 v97, v201, v218, v97
    v_dot2_f32_bf16 v98, v202, v218, v98
    v_dot2_f32_bf16 v99, v203, v218, v99
    v_dot2_f32_bf16 v100, v204, v218, v100
    v_dot2_f32_bf16 v101, v205, v218, v101
    v_dot2_f32_bf16 v102, v206, v218, v102
    v_dot2_f32_bf16 v103, v207, v218, v103
    v_perm_b32 v200, v156, v152, s20
    v_perm_b32 v201, v156, v152, s21
    v_perm_b32 v202, v157, v153, s20
    v_perm_b32 v203, v157, v153, s21
    v_perm_b32 v204, v158, v154, s20
    v_perm_b32 v205, v158, v154, s21
    v_perm_b32 v206, v159, v155, s20
    v_perm_b32 v207, v159, v155, s21
    v_dot2_f32_bf16 v96, v200, v219, v96
    v_dot2_f32_bf16 v97, v201, v219, v97
    v_dot2_f32_bf16 v98, v202, v219, v98
    v_dot2_f32_bf16 v99, v203, v219, v99
    v_dot2_f32_bf16 v100, v204, v219, v100
    v_dot2_f32_bf16 v101, v205, v219, v101
    v_dot2_f32_bf16 v102, v206, v219, v102
    v_dot2_f32_bf16 v103, v207, v219, v103
    s_nop 2
    v_add_f32_dpp v96, v96, v96 row_ror:8 row_mask:0xf bank_mask:0xf
    v_add_f32_dpp v97, v97, v97 row_ror:8 row_mask:0xf bank_mask:0xf
    v_add_f32_dpp v98, v98, v98 row_ror:8 row_mask:0xf bank_mask:0xf
    v_add_f32_dpp v99, v99, v99 row_ror:8 row_mask:0xf bank_mask:0xf
    v_add_f32_dpp v100, v100, v100 row_ror:8 row_mask:0xf bank_mask:0xf
    v_add_f32_dpp v101, v101, v101 row_ror:8 row_mask:0xf bank_mask:0xf
    v_add_f32_dpp v102, v102, v102 row_ror:8 row_mask:0xf bank_mask:0xf
    v_add_f32_dpp v103, v103, v103 row_ror:8 row_mask:0xf bank_mask:0xf
    v_add_f32_dpp v96, v96, v96 row_ror:4 row_mask:0xf bank_mask:0xf
    v_add_f32_dpp v97, v97, v97 row_ror:4 row_mask:0xf bank_mask:0xf
    v_add_f32_dpp v98, v98, v98 row_ror:4 row_mask:0xf bank_mask:0xf
    v_add_f32_dpp v99, v99, v99 row_ror:4 row_mask:0xf bank_mask:0xf
    v_add_f32_dpp v100, v100, v100 row_ror:4 row_mask:0xf bank_mask:0xf
    v_add_f32_dpp v101, v101, v101 row_ror:4 row_mask:0xf bank_mask:0xf
    v_add_f32_dpp v102, v102, v102 row_ror:4 row_mask:0xf bank_mask:0xf
    v_add_f32_dpp v103, v103, v103 row_ror:4 row_mask:0xf bank_mask:0xf
    v_add_f32_dpp v96, v96, v96 row_ror:2 row_mask:0xf bank_mask:0xf
    v_add_f32_dpp v97, v97, v97 row_ror:2 row_mask:0xf bank_mask:0xf
    v_add_f32_dpp v98, v98, v98 row_ror:2 row_mask:0xf bank_mask:0xf
    v_add_f32_dpp v99, v99, v99 row_ror:2 row_mask:0xf bank_mask:0xf
    v_add_f32_dpp v100, v100, v100 row_ror:2 row_mask:0xf bank_mask:0xf
    v_add_f32_dpp v101, v101, v101 row_ror:2 row_mask:0xf bank_mask:0xf
    v_add_f32_dpp v102, v102, v102 row_ror:2 row_mask:0xf bank_mask:0xf
    v_add_f32_dpp v103, v103, v103 row_ror:2 row_mask:0xf bank_mask:0xf
    v_add_f32_dpp v96, v96, v96 row_ror:1 row_mask:0xf bank_mask:0xf
    v_add_f32_dpp v97, v97, v97 row_ror:1 row_mask:0xf bank_mask:0xf
    v_add_f32_dpp v98, v98, v98 row_ror:1 row_mask:0xf bank_mask:0xf
    v_add_f32_dpp v99, v99, v99 row_ror:1 row_mask:0xf bank_mask:0xf
    v_add_f32_dpp v100, v100, v100 row_ror:1 row_mask:0xf bank_mask:0xf
    v_add_f32_dpp v101, v101, v101 row_ror:1 row_mask:0xf bank_mask:0xf
    v_add_f32_dpp v102, v102, v102 row_ror:1 row_mask:0xf bank_mask:0xf
    v_add_f32_dpp v103, v103, v103 row_ror:1 row_mask:0xf bank_mask:0xf
    v_add_f32_dpp v96, v96, v96 row_bcast:15 row_mask:0xa bank_mask:0xf
    v_add_f32_dpp v97, v97, v97 row_bcast:15 row_mask:0xa bank_mask:0xf
    v_add_f32_dpp v98, v98, v98 row_bcast:15 row_mask:0xa bank_mask:0xf
    v_add_f32_dpp v99, v99, v99 row_bcast:15 row_mask:0xa bank_mask:0xf
    v_add_f32_dpp v100, v100, v100 row_bcast:15 row_mask:0xa bank_mask:0xf
    v_add_f32_dpp v101, v101, v101 row_bcast:15 row_mask:0xa bank_mask:0xf
    v_add_f32_dpp v102, v102, v102 row_bcast:15 row_mask:0xa bank_mask:0xf
    v_add_f32_dpp v103, v103, v103 row_bcast:15 row_mask:0xa bank_mask:0xf
    v_add_f32_dpp v96, v96, v96 row_bcast:31 row_mask:0xc bank_mask:0xf
    v_add_f32_dpp v97, v97, v97 row_bcast:31 row_mask:0xc bank_mask:0xf
    v_add_f32_dpp v98, v98, v98 row_bcast:31 row_mask:0xc bank_mask:0xf
    v_add_f32_dpp v99, v99, v99 row_bcast:31 row_mask:0xc bank_mask:0xf
    v_add_f32_dpp v100, v100, v100 row_bcast:31 row_mask:0xc bank_mask:0xf
    v_add_f32_dpp v101, v101, v101 row_bcast:31 row_mask:0xc bank_mask:0xf
    v_add_f32_dpp v102, v102, v102 row_bcast:31 row_mask:0xc bank_mask:0xf
    v_add_f32_dpp v103, v103, v103 row_bcast:31 row_mask:0xc bank_mask:0xf
    v_cvt_pk_bf16_f32 v104, v96, v97
    v_cvt_pk_bf16_f32 v105, v98, v99
    v_cvt_pk_bf16_f32 v106, v100, v101
    v_cvt_pk_bf16_f32 v107, v102, v103
    v_lshlrev_b32 v96, 16, v104
    v_and_b32 v97, 0xffff0000, v104
    v_lshlrev_b32 v98, 16, v105
    v_and_b32 v99, 0xffff0000, v105
    v_lshlrev_b32 v100, 16, v106
    v_and_b32 v101, 0xffff0000, v106
    v_lshlrev_b32 v102, 16, v107
    v_and_b32 v103, 0xffff0000, v107
    v_add_f32 v96, s67, v96
    v_add_f32 v97, s67, v97
    v_add_f32 v98, s67, v98
    v_add_f32 v99, s67, v99
    v_add_f32 v100, s67, v100
    v_add_f32 v101, s67, v101
    v_add_f32 v102, s67, v102
    v_add_f32 v103, s67, v103
    v_cvt_pk_bf16_f32 v104, v96, v97
    v_cvt_pk_bf16_f32 v105, v98, v99
    v_cvt_pk_bf16_f32 v106, v100, v101
    v_cvt_pk_bf16_f32 v107, v102, v103
    v_lshlrev_b32 v96, 16, v104
    v_and_b32 v97, 0xffff0000, v104
    v_lshlrev_b32 v98, 16, v105
    v_and_b32 v99, 0xffff0000, v105
    v_lshlrev_b32 v100, 16, v106
    v_and_b32 v101, 0xffff0000, v106
    v_lshlrev_b32 v102, 16, v107
    v_and_b32 v103, 0xffff0000, v107
    v_mul_f32 v96, s69, v96
    v_mul_f32 v97, s69, v97
    v_mul_f32 v98, s69, v98
    v_mul_f32 v99, s69, v99
    v_mul_f32 v100, s69, v100
    v_mul_f32 v101, s69, v101
    v_mul_f32 v102, s69, v102
    v_mul_f32 v103, s69, v103
    s_mov_b32 exec_lo, 0
    s_mov_b32 exec_hi, 0x80000000
    global_store_dwordx4 v41, v[96:99], s[8:9] sc1
    global_store_dwordx4 v41, v[100:103], s[8:9] offset:16 sc1
    s_mov_b64 exec, -1
cde_nr:
    s_waitcnt vmcnt(0)
    s_mov_b64 exec, 1
    ds_add_u32 v28, v11 offset:56
    s_mov_b64 exec, -1
    s_branch cde_lw9e
cde_lw9:
    s_sleep 2
cde_lw9e:
    ds_read_b32 v29, v28 offset:192
    s_waitcnt lgkmcnt(0)
    v_readfirstlane_b32 s15, v29
    s_nop 0
    s_cmp_ge_u32 s15, 4
    s_cbranch_scc0 cde_lw9
    s_lshr_b32 s30, s14, 4
    s_and_b32 s31, s14, 15
    s_and_b32 s22, s23, 3
    s_and_b32 s35, s31, 7
    s_mul_i32 s32, s31, 3
    s_lshl_b32 s57, s31, 1
    s_add_u32 s57, s57, 11
    s_cmp_lt_u32 s31, 11
    s_cselect_b32 s32, s32, s57
    s_cselect_b32 s33, 1, 0
    s_mul_i32 s34, s22, 11
    s_lshl_b32 s24, s22, 12
    s_lshl_b32 s15, s30, 2
    s_add_u32 s38, s15, s22
    s_mul_i32 s45, s38, 88064
    s_lshl_b32 s57, s32, 10
    s_add_u32 s45, s45, s57
    s_add_u32 s45, s45, 12582912
    s_lshl_b32 s44, s30, 11
    s_add_u32 s44, s44, 32768
    s_mov_b32 s50, 0xa9764310
    s_mov_b32 s51, 0x852
    s_cmp_eq_u32 s22, 1
    s_cselect_b32 s50, 0xa875421, s50
    s_cselect_b32 s51, 0x963, s51
    s_cmp_eq_u32 s22, 2
    s_cselect_b32 s50, 0x19865320, s50
    s_cselect_b32 s51, 0xa74, s51
    s_cmp_eq_u32 s22, 3
    s_cselect_b32 s50, 0x65430210, s50
    s_cselect_b32 s51, 0x987, s51
    s_lshl_b32 s25, s34, 15
    s_lshl_b32 s57, s35, 7
    s_add_u32 s25, s25, s57
    v_lshrrev_b32 v26, 3, v1
    v_and_b32 v27, 7, v1
    v_lshlrev_b32 v26, 10, v26
    v_bfe_u32 v29, v1, 4, 2
    v_lshlrev_b32 v29, 1, v29
    v_xor_b32 v27, v27, v29
    v_lshl_add_u32 v26, v27, 4, v26
    v_add_u32 v27, 8192, v26
    s_movk_i32 s18, 2752
    s_lshl_b32 s19, s33, 2
    s_add_u32 s19, s19, 8
    v_add_u32 v12, 0, v1
    v_mul_u32_u24 v13, 0x1556, v12
    v_lshrrev_b32 v13, 16, v13
    v_mul_u32_u24 v14, 12, v13
    v_sub_u32 v14, v12, v14
    v_subrev_u32 v15, 8, v14
    v_cmp_le_u32 vcc, s19, v14
    s_nop 1
    v_cndmask_b32 v14, v14, v15, vcc
    v_lshlrev_b32 v14, 4, v14
    v_mad_u32_u24 v8, v13, s18, v14
    v_add_u32 v12, 64, v1
    v_mul_u32_u24 v13, 0x1556, v12
    v_lshrrev_b32 v13, 16, v13
    v_mul_u32_u24 v14, 12, v13
    v_sub_u32 v14, v12, v14
    v_subrev_u32 v15, 8, v14
    v_cmp_le_u32 vcc, s19, v14
    s_nop 1
    v_cndmask_b32 v14, v14, v15, vcc
    v_lshlrev_b32 v14, 4, v14
    v_mad_u32_u24 v9, v13, s18, v14
    v_add_u32 v12, 128, v1
    v_mul_u32_u24 v13, 0x1556, v12
    v_lshrrev_b32 v13, 16, v13
    v_mul_u32_u24 v14, 12, v13
    v_sub_u32 v14, v12, v14
    v_subrev_u32 v15, 8, v14
    v_cmp_le_u32 vcc, s19, v14
    s_nop 1
    v_cndmask_b32 v14, v14, v15, vcc
    v_lshlrev_b32 v14, 4, v14
    v_mad_u32_u24 v10, v13, s18, v14
    s_mul_i32 s18, s22, 88064
    s_lshl_b32 s57, s32, 6
    s_add_u32 s18, s18, s57
    s_mul_i32 s26, s22, 6144
    v_add_u32 v30, s24, v3
    v_add_u32 v31, 98304, v30
    v_add_u32 v32, 49152, v30
    s_add_u32 s10, s52, s18
    s_addc_u32 s11, s53, 0
    s_add_u32 m0, s26, 0
    s_nop 0
    global_load_lds_dwordx4 v8, s[10:11]
    s_add_u32 m0, s26, 1024
    s_nop 0
    global_load_lds_dwordx4 v9, s[10:11]
    s_add_u32 m0, s26, 2048
    s_nop 0
    global_load_lds_dwordx4 v10, s[10:11]
    s_add_u32 s10, s10, 44032
    s_addc_u32 s11, s11, 0
    s_add_u32 m0, s26, 3072
    s_nop 0
    global_load_lds_dwordx4 v8, s[10:11]
    s_add_u32 m0, s26, 4096
    s_nop 0
    global_load_lds_dwordx4 v9, s[10:11]
    s_add_u32 m0, s26, 5120
    s_nop 0
    global_load_lds_dwordx4 v10, s[10:11]
    s_add_u32 s10, s10, 308224
    s_addc_u32 s11, s11, 0
    s_add_u32 m0, s26, 24576
    s_nop 0
    global_load_lds_dwordx4 v8, s[10:11]
    s_add_u32 m0, s26, 25600
    s_nop 0
    global_load_lds_dwordx4 v9, s[10:11]
    s_add_u32 m0, s26, 26624
    s_nop 0
    global_load_lds_dwordx4 v10, s[10:11]
    s_add_u32 s10, s10, 44032
    s_addc_u32 s11, s11, 0
    s_add_u32 m0, s26, 27648
    s_nop 0
    global_load_lds_dwordx4 v8, s[10:11]
    s_add_u32 m0, s26, 28672
    s_nop 0
    global_load_lds_dwordx4 v9, s[10:11]
    s_add_u32 m0, s26, 29696
    s_nop 0
    global_load_lds_dwordx4 v10, s[10:11]
    s_add_u32 s10, s10, 308224
    s_addc_u32 s11, s11, 0
    s_branch cde_lw10e
cde_lw10:
    s_sleep 2
cde_lw10e:
    ds_read_b32 v29, v28 offset:208
    s_waitcnt lgkmcnt(0)
    v_readfirstlane_b32 s15, v29
    s_nop 0
    s_cmp_ge_u32 s15, 4
    s_cbranch_scc0 cde_lw10
    s_add_u32 m0, s26, 49152
    s_nop 0
    global_load_lds_dwordx4 v8, s[10:11]
    s_add_u32 m0, s26, 50176
    s_nop 0
    global_load_lds_dwordx4 v9, s[10:11]
    s_add_u32 m0, s26, 51200
    s_nop 0
    global_load_lds_dwordx4 v10, s[10:11]
    s_add_u32 s10, s10, 44032
    s_addc_u32 s11, s11, 0
    s_add_u32 m0, s26, 52224
    s_nop 0
    global_load_lds_dwordx4 v8, s[10:11]
    s_add_u32 m0, s26, 53248
    s_nop 0
    global_load_lds_dwordx4 v9, s[10:11]
    s_add_u32 m0, s26, 54272
    s_nop 0
    global_load_lds_dwordx4 v10, s[10:11]
    s_add_u32 s10, s10, 308224
    s_addc_u32 s11, s11, 0
    s_add_u32 m0, s26, 73728
    s_nop 0
    global_load_lds_dwordx4 v8, s[10:11]
    s_add_u32 m0, s26, 74752
    s_nop 0
    global_load_lds_dwordx4 v9, s[10:11]
    s_add_u32 m0, s26, 75776
    s_nop 0
    global_load_lds_dwordx4 v10, s[10:11]
    s_add_u32 s10, s10, 44032
    s_addc_u32 s11, s11, 0
    s_add_u32 m0, s26, 76800
    s_nop 0
    global_load_lds_dwordx4 v8, s[10:11]
    s_add_u32 m0, s26, 77824
    s_nop 0
    global_load_lds_dwordx4 v9, s[10:11]
    s_add_u32 m0, s26, 78848
    s_nop 0
    global_load_lds_dwordx4 v10, s[10:11]
    s_lshl_b32 s15, s22, 5
    s_add_u32 s15, s15, 110656
    v_mov_b32 v33, s15
    s_add_u32 s36, s8, s44
    s_addc_u32 s37, s9, 0
    v_lshrrev_b32 v34, 2, v1
    v_lshlrev_b32 v34, 7, v34
    v_and_b32 v35, 3, v1
    v_lshl_add_u32 v34, v35, 4, v34
    s_lshl_b32 s15, s31, 7
    s_lshl_b32 s57, s22, 4
    s_add_u32 s15, s15, s57
    v_mov_b32 v35, s15
    v_bfe_u32 v36, v1, 4, 1
    v_mul_u32_u24 v36, 44032, v36
    v_lshrrev_b32 v37, 5, v1
    v_lshl_add_u32 v36, v37, 8, v36
    v_and_b32 v37, 15, v1
    v_lshl_add_u32 v36, v37, 4, v36
    s_add_u32 s46, s8, s45
    s_addc_u32 s47, s9, 0
    s_bfe_u32 s57, s50, 0x40004
    s_lshl_b32 s57, s57, 15
    s_add_u32 s57, s57, s25
    s_add_u32 s28, s54, s57
    s_addc_u32 s29, s55, 0
    s_add_u32 m0, s24, 114688
    s_nop 0
    global_load_lds_dwordx4 v26, s[28:29]
    s_add_u32 m0, s24, 115712
    s_nop 0
    global_load_lds_dwordx4 v27, s[28:29]
    s_add_u32 s28, s28, 16384
    s_addc_u32 s29, s29, 0
    s_add_u32 m0, s24, 116736
    s_nop 0
    global_load_lds_dwordx4 v26, s[28:29]
    s_add_u32 m0, s24, 117760
    s_nop 0
    global_load_lds_dwordx4 v27, s[28:29]
    s_waitcnt vmcnt(4)
    s_mov_b64 exec, 1
    ds_add_u32 v28, v11 offset:8
    s_mov_b64 exec, -1
    s_cmp_lt_u32 s22, 3
    s_cbranch_scc0 cde_no0
    s_bfe_u32 s57, s50, 0x4000c
    s_lshl_b32 s57, s57, 15
    s_add_u32 s57, s57, s25
    s_add_u32 s28, s54, s57
    s_addc_u32 s29, s55, 0
    s_add_u32 m0, s24, 98304
    s_nop 0
    global_load_lds_dwordx4 v26, s[28:29]
    s_add_u32 m0, s24, 99328
    s_nop 0
    global_load_lds_dwordx4 v27, s[28:29]
    s_add_u32 s28, s28, 16384
    s_addc_u32 s29, s29, 0
    s_add_u32 m0, s24, 100352
    s_nop 0
    global_load_lds_dwordx4 v26, s[28:29]
    s_add_u32 m0, s24, 101376
    s_nop 0
    global_load_lds_dwordx4 v27, s[28:29]
cde_no0:
    s_bfe_u32 s57, s50, 0x40000
    s_lshl_b32 s57, s57, 15
    s_add_u32 s57, s57, s25
    s_add_u32 s28, s54, s57
    s_addc_u32 s29, s55, 0
    global_load_dwordx4 v[64:67], v26, s[28:29] offset:0
    global_load_dwordx4 v[68:71], v27, s[28:29] offset:0
    s_add_u32 s28, s28, 16384
    s_addc_u32 s29, s29, 0
    global_load_dwordx4 v[72:75], v26, s[28:29] offset:0
    global_load_dwordx4 v[76:79], v27, s[28:29] offset:0
    s_bfe_u32 s57, s50, 0x40010
    s_lshl_b32 s57, s57, 15
    s_add_u32 s57, s57, s25
    s_add_u32 s28, s54, s57
    s_addc_u32 s29, s55, 0
    global_load_dwordx4 v[80:83], v26, s[28:29] offset:0
    global_load_dwordx4 v[84:87], v27, s[28:29] offset:0
    s_add_u32 s28, s28, 16384
    s_addc_u32 s29, s29, 0
    global_load_dwordx4 v[88:91], v26, s[28:29] offset:0
    global_load_dwordx4 v[92:95], v27, s[28:29] offset:0
    s_bfe_u32 s57, s50, 0x40014
    s_lshl_b32 s57, s57, 15
    s_add_u32 s57, s57, s25
    s_add_u32 s28, s54, s57
    s_addc_u32 s29, s55, 0
    global_load_dwordx4 v[96:99], v26, s[28:29] offset:0
    global_load_dwordx4 v[100:103], v27, s[28:29] offset:0
    s_add_u32 s28, s28, 16384
    s_addc_u32 s29, s29, 0
    global_load_dwordx4 v[104:107], v26, s[28:29] offset:0
    global_load_dwordx4 v[108:111], v27, s[28:29] offset:0
    s_branch cde_lw11e
cde_lw11:
    s_sleep 2
cde_lw11e:
    ds_read_b32 v29, v28 offset:16
    s_waitcnt lgkmcnt(0)
    v_readfirstlane_b32 s15, v29
    s_nop 0
    s_cmp_ge_u32 s15, 4
    s_cbranch_scc0 cde_lw11
    s_bfe_u32 s57, s50, 0x40008
    s_lshl_b32 s57, s57, 15
    s_add_u32 s57, s57, s25
    s_add_u32 s28, s54, s57
    s_addc_u32 s29, s55, 0
    s_add_u32 m0, s24, 131072
    s_nop 0
    global_load_lds_dwordx4 v26, s[28:29]
    s_add_u32 m0, s24, 132096
    s_nop 0
    global_load_lds_dwordx4 v27, s[28:29]
    s_add_u32 s28, s28, 16384
    s_addc_u32 s29, s29, 0
    s_add_u32 m0, s24, 133120
    s_nop 0
    global_load_lds_dwordx4 v26, s[28:29]
    s_add_u32 m0, s24, 134144
    s_nop 0
    global_load_lds_dwordx4 v27, s[28:29]
    global_load_dword v38, v34, s[36:37] offset:8 sc1
    s_bfe_u32 s57, s50, 0x40018
    s_lshl_b32 s57, s57, 15
    s_add_u32 s57, s57, s25
    s_add_u32 s28, s54, s57
    s_addc_u32 s29, s55, 0
    global_load_dwordx4 v[112:115], v26, s[28:29] offset:0
    global_load_dwordx4 v[116:119], v27, s[28:29] offset:0
    s_add_u32 s28, s28, 16384
    s_addc_u32 s29, s29, 0
    global_load_dwordx4 v[120:123], v26, s[28:29] offset:0
    global_load_dwordx4 v[124:127], v27, s[28:29] offset:0
    s_bfe_u32 s57, s50, 0x4001c
    s_lshl_b32 s57, s57, 15
    s_add_u32 s57, s57, s25
    s_add_u32 s28, s54, s57
    s_addc_u32 s29, s55, 0
    global_load_dwordx4 v[128:131], v26, s[28:29] offset:0
    global_load_dwordx4 v[132:135], v27, s[28:29] offset:0
    s_add_u32 s28, s28, 16384
    s_addc_u32 s29, s29, 0
    global_load_dwordx4 v[136:139], v26, s[28:29] offset:0
    global_load_dwordx4 v[140:143], v27, s[28:29] offset:0
    s_branch cde_lw12e
cde_lw12:
    s_sleep 2
cde_lw12e:
    ds_read_b32 v29, v28 offset:48
    s_waitcnt lgkmcnt(0)
    v_readfirstlane_b32 s15, v29
    s_nop 0
    s_cmp_ge_u32 s15, 4
    s_cbranch_scc0 cde_lw12
    s_waitcnt vmcnt(8)
    ds_write_b128 v31, v[64:67] offset:49152
    ds_write_b128 v31, v[68:71] offset:50176
    ds_write_b128 v31, v[72:75] offset:51200
    ds_write_b128 v31, v[76:79] offset:52224
    v_cmp_ne_u32 vcc, s56, v38
    s_nop 0
    s_mov_b64 s[58:59], vcc
    s_waitcnt lgkmcnt(0)
    s_mov_b64 exec, 1
    ds_add_u32 v33, v11 offset:0
    s_mov_b64 exec, -1
    s_branch cde_lw13e
cde_lw13:
    s_sleep 2
cde_lw13e:
    ds_read_b32 v29, v33 offset:24
    s_waitcnt lgkmcnt(0)
    v_readfirstlane_b32 s15, v29
    s_nop 0
    s_cmp_ge_u32 s15, 1
    s_cbranch_scc0 cde_lw13
    s_setprio 2
    s_bfe_u32 s57, s51, 0x40000
    s_lshl_b32 s57, s57, 15
    s_add_u32 s57, s57, s25
    s_add_u32 s28, s54, s57
    s_addc_u32 s29, s55, 0
    global_load_dwordx4 v[144:147], v26, s[28:29] offset:0
    global_load_dwordx4 v[148:151], v27, s[28:29] offset:0
    s_add_u32 s28, s28, 16384
    s_addc_u32 s29, s29, 0
    global_load_dwordx4 v[152:155], v26, s[28:29] offset:0
    global_load_dwordx4 v[156:159], v27, s[28:29] offset:0
    s_bfe_u32 s57, s51, 0x40004
    s_lshl_b32 s57, s57, 15
    s_add_u32 s57, s57, s25
    s_add_u32 s28, s54, s57
    s_addc_u32 s29, s55, 0
    global_load_dwordx4 v[160:163], v26, s[28:29] offset:0
    global_load_dwordx4 v[164:167], v27, s[28:29] offset:0
    s_add_u32 s28, s28, 16384
    s_addc_u32 s29, s29, 0
    global_load_dwordx4 v[168:171], v26, s[28:29] offset:0
    global_load_dwordx4 v[172:175], v27, s[28:29] offset:0
    s_bfe_u32 s57, s51, 0x40008
    s_lshl_b32 s57, s57, 15
    s_add_u32 s57, s57, s25
    s_add_u32 s28, s54, s57
    s_addc_u32 s29, s55, 0
    global_load_dwordx4 v[176:179], v26, s[28:29] offset:0
    global_load_dwordx4 v[180:183], v27, s[28:29] offset:0
    s_add_u32 s28, s28, 16384
    s_addc_u32 s29, s29, 0
    global_load_dwordx4 v[184:187], v26, s[28:29] offset:0
    global_load_dwordx4 v[188:191], v27, s[28:29] offset:0
cde_lw14:
    ds_read_b32 v29, v33 offset:4
    s_waitcnt lgkmcnt(0)
    v_readfirstlane_b32 s15, v29
    s_nop 0
    s_cmp_ge_u32 s15, 1
    s_cbranch_scc0 cde_lw14
    ds_read_b128 v[40:43], v31 offset:49152
    ds_read_b128 v[44:47], v31 offset:50176
    s_waitcnt lgkmcnt(0)
    v_lshlrev_b32 v192, 16, v40
    v_and_b32 v193, 0xffff0000, v40
    v_lshlrev_b32 v194, 16, v41
    v_and_b32 v195, 0xffff0000, v41
    v_lshlrev_b32 v196, 16, v42
    v_and_b32 v197, 0xffff0000, v42
    v_lshlrev_b32 v198, 16, v43
    v_and_b32 v199, 0xffff0000, v43
    v_lshlrev_b32 v200, 16, v44
    v_and_b32 v201, 0xffff0000, v44
    v_lshlrev_b32 v202, 16, v45
    v_and_b32 v203, 0xffff0000, v45
    v_lshlrev_b32 v204, 16, v46
    v_and_b32 v205, 0xffff0000, v46
    v_lshlrev_b32 v206, 16, v47
    v_and_b32 v207, 0xffff0000, v47
    v_exp_f32 v208, v192
    v_exp_f32 v209, v193
    v_exp_f32 v210, v194
    v_exp_f32 v211, v195
    v_exp_f32 v212, v196
    v_exp_f32 v213, v197
    v_exp_f32 v214, v198
    v_exp_f32 v215, v199
    v_exp_f32 v216, v200
    v_exp_f32 v217, v201
    v_exp_f32 v218, v202
    v_exp_f32 v219, v203
    v_exp_f32 v220, v204
    v_exp_f32 v221, v205
    v_exp_f32 v222, v206
    v_exp_f32 v223, v207
    v_pk_add_f32 v[208:209], v[208:209], 1.0 op_sel_hi:[1,0]
    v_pk_add_f32 v[210:211], v[210:211], 1.0 op_sel_hi:[1,0]
    v_pk_add_f32 v[212:213], v[212:213], 1.0 op_sel_hi:[1,0]
    v_pk_add_f32 v[214:215], v[214:215], 1.0 op_sel_hi:[1,0]
    v_pk_add_f32 v[216:217], v[216:217], 1.0 op_sel_hi:[1,0]
    v_pk_add_f32 v[218:219], v[218:219], 1.0 op_sel_hi:[1,0]
    v_pk_add_f32 v[220:221], v[220:221], 1.0 op_sel_hi:[1,0]
    v_pk_add_f32 v[222:223], v[222:223], 1.0 op_sel_hi:[1,0]
    v_rcp_f32 v208, v208
    v_rcp_f32 v209, v209
    v_rcp_f32 v210, v210
    v_rcp_f32 v211, v211
    v_rcp_f32 v212, v212
    v_rcp_f32 v213, v213
    v_rcp_f32 v214, v214
    v_rcp_f32 v215, v215
    v_rcp_f32 v216, v216
    v_rcp_f32 v217, v217
    v_rcp_f32 v218, v218
    v_rcp_f32 v219, v219
    v_rcp_f32 v220, v220
    v_rcp_f32 v221, v221
    v_rcp_f32 v222, v222
    v_rcp_f32 v223, v223
    v_pk_mul_f32 v[192:193], v[192:193], v[208:209]
    v_pk_mul_f32 v[194:195], v[194:195], v[210:211]
    v_pk_mul_f32 v[196:197], v[196:197], v[212:213]
    v_pk_mul_f32 v[198:199], v[198:199], v[214:215]
    v_pk_mul_f32 v[200:201], v[200:201], v[216:217]
    v_pk_mul_f32 v[202:203], v[202:203], v[218:219]
    v_pk_mul_f32 v[204:205], v[204:205], v[220:221]
    v_pk_mul_f32 v[206:207], v[206:207], v[222:223]
    v_cvt_pk_bf16_f32 v48, v192, v193
    v_cvt_pk_bf16_f32 v49, v194, v195
    v_cvt_pk_bf16_f32 v50, v196, v197
    v_cvt_pk_bf16_f32 v51, v198, v199
    v_cvt_pk_bf16_f32 v52, v200, v201
    v_cvt_pk_bf16_f32 v53, v202, v203
    v_cvt_pk_bf16_f32 v54, v204, v205
    v_cvt_pk_bf16_f32 v55, v206, v207
    global_store_dwordx4 v36, v[48:51], s[46:47] offset:0 sc1
    global_store_dwordx4 v36, v[52:55], s[46:47] offset:512 sc1
    s_waitcnt vmcnt(0)
    s_mov_b64 exec, 1
    s_cbranch_vccnz cde_sl15
    global_store_dword v35, v11, s[36:37] offset:4
cde_bk16:
    s_mov_b64 exec, -1
    s_cmp_eq_u32 s33, 0
    s_cbranch_scc1 cde_lno2
cde_lw17:
    ds_read_b32 v29, v33 offset:4
    s_waitcnt lgkmcnt(0)
    v_readfirstlane_b32 s15, v29
    s_nop 0
    s_cmp_ge_u32 s15, 2
    s_cbranch_scc0 cde_lw17
    ds_read_b128 v[40:43], v31 offset:51200
    ds_read_b128 v[44:47], v31 offset:52224
    s_waitcnt lgkmcnt(0)
    v_lshlrev_b32 v192, 16, v40
    v_and_b32 v193, 0xffff0000, v40
    v_lshlrev_b32 v194, 16, v41
    v_and_b32 v195, 0xffff0000, v41
    v_lshlrev_b32 v196, 16, v42
    v_and_b32 v197, 0xffff0000, v42
    v_lshlrev_b32 v198, 16, v43
    v_and_b32 v199, 0xffff0000, v43
    v_lshlrev_b32 v200, 16, v44
    v_and_b32 v201, 0xffff0000, v44
    v_lshlrev_b32 v202, 16, v45
    v_and_b32 v203, 0xffff0000, v45
    v_lshlrev_b32 v204, 16, v46
    v_and_b32 v205, 0xffff0000, v46
    v_lshlrev_b32 v206, 16, v47
    v_and_b32 v207, 0xffff0000, v47
    v_exp_f32 v208, v192
    v_exp_f32 v209, v193
    v_exp_f32 v210, v194
    v_exp_f32 v211, v195
    v_exp_f32 v212, v196
    v_exp_f32 v213, v197
    v_exp_f32 v214, v198
    v_exp_f32 v215, v199
    v_exp_f32 v216, v200
    v_exp_f32 v217, v201
    v_exp_f32 v218, v202
    v_exp_f32 v219, v203
    v_exp_f32 v220, v204
    v_exp_f32 v221, v205
    v_exp_f32 v222, v206
    v_exp_f32 v223, v207
    v_pk_add_f32 v[208:209], v[208:209], 1.0 op_sel_hi:[1,0]
    v_pk_add_f32 v[210:211], v[210:211], 1.0 op_sel_hi:[1,0]
    v_pk_add_f32 v[212:213], v[212:213], 1.0 op_sel_hi:[1,0]
    v_pk_add_f32 v[214:215], v[214:215], 1.0 op_sel_hi:[1,0]
    v_pk_add_f32 v[216:217], v[216:217], 1.0 op_sel_hi:[1,0]
    v_pk_add_f32 v[218:219], v[218:219], 1.0 op_sel_hi:[1,0]
    v_pk_add_f32 v[220:221], v[220:221], 1.0 op_sel_hi:[1,0]
    v_pk_add_f32 v[222:223], v[222:223], 1.0 op_sel_hi:[1,0]
    v_rcp_f32 v208, v208
    v_rcp_f32 v209, v209
    v_rcp_f32 v210, v210
    v_rcp_f32 v211, v211
    v_rcp_f32 v212, v212
    v_rcp_f32 v213, v213
    v_rcp_f32 v214, v214
    v_rcp_f32 v215, v215
    v_rcp_f32 v216, v216
    v_rcp_f32 v217, v217
    v_rcp_f32 v218, v218
    v_rcp_f32 v219, v219
    v_rcp_f32 v220, v220
    v_rcp_f32 v221, v221
    v_rcp_f32 v222, v222
    v_rcp_f32 v223, v223
    v_pk_mul_f32 v[192:193], v[192:193], v[208:209]
    v_pk_mul_f32 v[194:195], v[194:195], v[210:211]
    v_pk_mul_f32 v[196:197], v[196:197], v[212:213]
    v_pk_mul_f32 v[198:199], v[198:199], v[214:215]
    v_pk_mul_f32 v[200:201], v[200:201], v[216:217]
    v_pk_mul_f32 v[202:203], v[202:203], v[218:219]
    v_pk_mul_f32 v[204:205], v[204:205], v[220:221]
    v_pk_mul_f32 v[206:207], v[206:207], v[222:223]
    v_cvt_pk_bf16_f32 v56, v192, v193
    v_cvt_pk_bf16_f32 v57, v194, v195
    v_cvt_pk_bf16_f32 v58, v196, v197
    v_cvt_pk_bf16_f32 v59, v198, v199
    v_cvt_pk_bf16_f32 v60, v200, v201
    v_cvt_pk_bf16_f32 v61, v202, v203
    v_cvt_pk_bf16_f32 v62, v204, v205
    v_cvt_pk_bf16_f32 v63, v206, v207
    global_store_dwordx4 v36, v[56:59], s[46:47] offset:2048 sc1
    global_store_dwordx4 v36, v[60:63], s[46:47] offset:2560 sc1
cde_lno2:
    s_setprio 0
cde_lw18:
    ds_read_b32 v29, v28 offset:52
    s_waitcnt lgkmcnt(0)
    v_readfirstlane_b32 s15, v29
    s_nop 0
    s_cmp_ge_u32 s15, 4
    s_cbranch_scc0 cde_lw18
    ds_write_b128 v31, v[80:83] offset:49152
    ds_write_b128 v31, v[84:87] offset:50176
    ds_write_b128 v31, v[88:91] offset:51200
    ds_write_b128 v31, v[92:95] offset:52224
    ds_write_b128 v30, v[96:99] offset:0
    ds_write_b128 v30, v[100:103] offset:1024
    ds_write_b128 v30, v[104:107] offset:2048
    ds_write_b128 v30, v[108:111] offset:3072
    ds_write_b128 v30, v[112:115] offset:16384
    ds_write_b128 v30, v[116:119] offset:17408
    ds_write_b128 v30, v[120:123] offset:18432
    ds_write_b128 v30, v[124:127] offset:19456
    ds_write_b128 v30, v[128:131] offset:32768
    ds_write_b128 v30, v[132:135] offset:33792
    ds_write_b128 v30, v[136:139] offset:34816
    ds_write_b128 v30, v[140:143] offset:35840
    ds_write_b128 v32, v[144:147] offset:0
    ds_write_b128 v32, v[148:151] offset:1024
    ds_write_b128 v32, v[152:155] offset:2048
    ds_write_b128 v32, v[156:159] offset:3072
    ds_write_b128 v32, v[160:163] offset:16384
    ds_write_b128 v32, v[164:167] offset:17408
    ds_write_b128 v32, v[168:171] offset:18432
    ds_write_b128 v32, v[172:175] offset:19456
    ds_write_b128 v32, v[176:179] offset:32768
    ds_write_b128 v32, v[180:183] offset:33792
    ds_write_b128 v32, v[184:187] offset:34816
    ds_write_b128 v32, v[188:191] offset:35840
    s_waitcnt vmcnt(0)
    s_mov_b64 exec, 1
    s_cbranch_vccnz cde_sl19
    global_store_dword v35, v11, s[36:37] offset:12
cde_bk20:
    s_mov_b64 exec, -1
    s_waitcnt lgkmcnt(0)
    s_mov_b64 exec, 1
    ds_add_u32 v33, v11 offset:16
    s_mov_b64 exec, -1
    s_movk_i32 s57, 0x7fff
cde_f2:
    global_load_dwordx4 v[40:43], v34, s[36:37] sc1
    s_waitcnt vmcnt(0)
    v_mul_u32_u24 v40, v40, v43
    v_cmp_eq_u32 vcc, 2, v40
    s_nop 0
    s_cmp_eq_u64 vcc, -1
    s_cbranch_scc1 cde_f2_ok
    s_sub_u32 s57, s57, 1
    s_cmp_lg_u32 s57, 0
    s_cbranch_scc1 cde_f2
cde_f2_ok:
    s_mov_b64 exec, 1
    ds_add_u32 v33, v11 offset:20
    s_mov_b64 exec, -1
    s_waitcnt lgkmcnt(0)
    s_endpgm
cde_A:
    v_and_b32 v8, 15, v1
    v_lshrrev_b32 v9, 4, v1
    v_lshl_add_u32 v8, v2, 4, v8
    v_lshrrev_b32 v166, 1, v9
    v_lshlrev_b32 v166, 19, v166
    v_and_b32 v7, 1, v9
    v_lshl_add_u32 v166, v7, 10, v166
    v_lshl_add_u32 v166, v8, 4, v166
    s_lshl_b32 s57, s14, 11
    v_add_u32 v166, s57, v166
    v_add_u32 v167, 0x100000, v166
    v_lshlrev_b32 v6, 5, v8
    v_add_u32 v6, 4096, v6
    v_add_u32 v7, 4096, v6
    v_lshlrev_b32 v164, 13, v208
    v_lshl_add_u32 v164, v210, 4, v164
    v_lshlrev_b32 v165, 13, v209
    v_xor_b32 v4, 1, v210
    v_lshl_add_u32 v165, v4, 4, v165
    s_lshl_b32 s15, s14, 5
    s_add_u32 s48, s20, s15
    s_addc_u32 s49, s21, 0
    s_lshl_b32 s15, s14, 13
    s_add_u32 s15, s15, 1048576
    s_add_u32 s16, s8, s15
    s_addc_u32 s17, s9, 0
    v_and_b32 v152, 7, v8
    v_bfe_u32 v153, v8, 3, 1
    v_cvt_f32_u32 v152, v152
    v_cvt_f32_u32 v153, v153
    v_cvt_f32_u32 v154, v9
    v_mul_f32 v155, 0x3e000000, v152
    v_mul_f32 v156, v155, v154
    v_fmamk_f32 v157, v155, 0xc0e00000, v156
    v_mul_f32 v158, 0x3e800000, v153
    v_add_f32 v159, 0.5, v158
    v_cos_f32 v30, v156
    v_sin_f32 v31, v156
    s_nop 0
    v_cvt_pk_bf16_f32 v32, v30, -v31
    v_cvt_pk_bf16_f32 v40, v31, v30
    v_fmamk_f32 v29, v158, 0x3f800000, v156
    v_cos_f32 v30, v29
    v_sin_f32 v31, v29
    s_nop 0
    v_cvt_pk_bf16_f32 v33, v30, -v31
    v_cvt_pk_bf16_f32 v41, v31, v30
    v_fmamk_f32 v29, v158, 0x40000000, v156
    v_cos_f32 v30, v29
    v_sin_f32 v31, v29
    s_nop 0
    v_cvt_pk_bf16_f32 v34, v30, -v31
    v_cvt_pk_bf16_f32 v42, v31, v30
    v_fmamk_f32 v29, v158, 0x40400000, v156
    v_cos_f32 v30, v29
    v_sin_f32 v31, v29
    s_nop 0
    v_cvt_pk_bf16_f32 v35, v30, -v31
    v_cvt_pk_bf16_f32 v43, v31, v30
    v_cos_f32 v30, v156
    v_sin_f32 v31, v156
    s_nop 0
    v_cvt_pk_bf16_f32 v48, v30, -v31
    v_cvt_pk_bf16_f32 v56, v31, v30
    v_fmamk_f32 v29, v159, 0x3f800000, v156
    v_cos_f32 v30, v29
    v_sin_f32 v31, v29
    s_nop 0
    v_cvt_pk_bf16_f32 v49, v30, -v31
    v_cvt_pk_bf16_f32 v57, v31, v30
    v_fmamk_f32 v29, v159, 0x40000000, v156
    v_cos_f32 v30, v29
    v_sin_f32 v31, v29
    s_nop 0
    v_cvt_pk_bf16_f32 v50, v30, -v31
    v_cvt_pk_bf16_f32 v58, v31, v30
    v_fmamk_f32 v29, v159, 0x40400000, v156
    v_cos_f32 v30, v29
    v_sin_f32 v31, v29
    s_nop 0
    v_cvt_pk_bf16_f32 v51, v30, -v31
    v_cvt_pk_bf16_f32 v59, v31, v30
    v_cos_f32 v30, v157
    v_sin_f32 v31, v157
    s_nop 0
    v_cvt_pk_bf16_f32 v36, v30, -v31
    v_cvt_pk_bf16_f32 v44, -v31, -v30
    v_fmamk_f32 v29, v158, 0x3f800000, v157
    v_cos_f32 v30, v29
    v_sin_f32 v31, v29
    s_nop 0
    v_cvt_pk_bf16_f32 v37, v30, -v31
    v_cvt_pk_bf16_f32 v45, -v31, -v30
    v_fmamk_f32 v29, v158, 0x40000000, v157
    v_cos_f32 v30, v29
    v_sin_f32 v31, v29
    s_nop 0
    v_cvt_pk_bf16_f32 v38, v30, -v31
    v_cvt_pk_bf16_f32 v46, -v31, -v30
    v_fmamk_f32 v29, v158, 0x40400000, v157
    v_cos_f32 v30, v29
    v_sin_f32 v31, v29
    s_nop 0
    v_cvt_pk_bf16_f32 v39, v30, -v31
    v_cvt_pk_bf16_f32 v47, -v31, -v30
    v_cos_f32 v30, v157
    v_sin_f32 v31, v157
    s_nop 0
    v_cvt_pk_bf16_f32 v52, v30, -v31
    v_cvt_pk_bf16_f32 v60, -v31, -v30
    v_fmamk_f32 v29, v159, 0x3f800000, v157
    v_cos_f32 v30, v29
    v_sin_f32 v31, v29
    s_nop 0
    v_cvt_pk_bf16_f32 v53, v30, -v31
    v_cvt_pk_bf16_f32 v61, -v31, -v30
    v_fmamk_f32 v29, v159, 0x40000000, v157
    v_cos_f32 v30, v29
    v_sin_f32 v31, v29
    s_nop 0
    v_cvt_pk_bf16_f32 v54, v30, -v31
    v_cvt_pk_bf16_f32 v62, -v31, -v30
    v_fmamk_f32 v29, v159, 0x40400000, v157
    v_cos_f32 v30, v29
    v_sin_f32 v31, v29
    s_nop 0
    v_cvt_pk_bf16_f32 v55, v30, -v31
    v_cvt_pk_bf16_f32 v63, -v31, -v30
    v_cvt_f32_u32 v153, v2
    v_mul_f32 v155, 0x3b000000, v152
    v_fma_f32 v153, v153, 4.0, v154
    v_add_f32 v153, v153, v153
    v_sub_f32 v156, 0x42800000, v153
    v_cmp_eq_f32 vcc, 0, v153
    v_mov_b32 v157, 0x42000000
    s_nop 0
    v_cndmask_b32 v156, v156, v157, vcc
    v_add_f32 v157, 1.0, v153
    v_sub_f32 v158, 0x427c0000, v153
    v_mul_f32 v29, v155, v153
    v_cos_f32 v64, v29
    v_sin_f32 v68, v29
    v_mul_f32 v29, v155, v156
    v_cos_f32 v65, v29
    v_sin_f32 v69, v29
    v_mul_f32 v29, v155, v157
    v_cos_f32 v66, v29
    v_sin_f32 v70, v29
    v_mul_f32 v29, v155, v158
    v_cos_f32 v67, v29
    v_sin_f32 v71, v29
    v_cvt_f32_u32 v155, v8
    v_mul_f32 v155, 0x3c800000, v155
    v_mul_f32 v156, v155, v154
    v_add_f32 v156, v156, v156
    v_sub_f32 v157, 0, v156
    v_mul_f32 v158, 0x42000000, v155
    v_cmp_eq_u32 vcc, 0, v9
    s_nop 1
    v_cndmask_b32 v158, v157, v158, vcc
    v_cos_f32 v30, v156
    v_sin_f32 v31, v156
    s_nop 0
    v_cvt_pk_bf16_f32 v72, v30, -v31
    v_cvt_pk_bf16_f32 v88, v31, v30
    v_cos_f32 v30, v158
    v_sin_f32 v31, v158
    s_nop 0
    v_cvt_pk_bf16_f32 v73, v30, -v31
    v_cvt_pk_bf16_f32 v89, v31, v30
    v_fmamk_f32 v29, v155, 0x3f800000, v156
    v_cos_f32 v30, v29
    v_sin_f32 v31, v29
    s_nop 0
    v_cvt_pk_bf16_f32 v74, v30, -v31
    v_cvt_pk_bf16_f32 v90, v31, v30
    v_fmamk_f32 v29, v155, 0xbf800000, v157
    v_cos_f32 v30, v29
    v_sin_f32 v31, v29
    s_nop 0
    v_cvt_pk_bf16_f32 v75, v30, -v31
    v_cvt_pk_bf16_f32 v91, v31, v30
    v_fmamk_f32 v29, v155, 0x41000000, v156
    v_cos_f32 v30, v29
    v_sin_f32 v31, v29
    s_nop 0
    v_cvt_pk_bf16_f32 v76, v30, -v31
    v_cvt_pk_bf16_f32 v92, v31, v30
    v_fmamk_f32 v29, v155, 0xc1000000, v157
    v_cos_f32 v30, v29
    v_sin_f32 v31, v29
    s_nop 0
    v_cvt_pk_bf16_f32 v77, v30, -v31
    v_cvt_pk_bf16_f32 v93, v31, v30
    v_fmamk_f32 v29, v155, 0x41100000, v156
    v_cos_f32 v30, v29
    v_sin_f32 v31, v29
    s_nop 0
    v_cvt_pk_bf16_f32 v78, v30, -v31
    v_cvt_pk_bf16_f32 v94, v31, v30
    v_fmamk_f32 v29, v155, 0xc1100000, v157
    v_cos_f32 v30, v29
    v_sin_f32 v31, v29
    s_nop 0
    v_cvt_pk_bf16_f32 v79, v30, -v31
    v_cvt_pk_bf16_f32 v95, v31, v30
    v_lshl_add_u32 v4, v2, 11, v3
    v_add_u32 v4, 147456, v4
    v_add_u32 v10, 147456, v3
    s_waitcnt vmcnt(0)
    s_sleep 4
    global_load_dwordx4 v[12:15], v164, s[48:49] offset:0 sc1
    global_load_dwordx4 v[16:19], v165, s[48:49] offset:0 sc1
    v_fmamk_f32 v29, v155, 0x41800000, v156
    v_cos_f32 v30, v29
    v_sin_f32 v31, v29
    s_nop 0
    v_cvt_pk_bf16_f32 v80, v30, -v31
    v_cvt_pk_bf16_f32 v96, v31, v30
    v_fmamk_f32 v29, v155, 0xc1800000, v157
    v_cos_f32 v30, v29
    v_sin_f32 v31, v29
    s_nop 0
    v_cvt_pk_bf16_f32 v81, v30, -v31
    v_cvt_pk_bf16_f32 v97, v31, v30
    v_fmamk_f32 v29, v155, 0x41880000, v156
    v_cos_f32 v30, v29
    v_sin_f32 v31, v29
    s_nop 0
    v_cvt_pk_bf16_f32 v82, v30, -v31
    v_cvt_pk_bf16_f32 v98, v31, v30
    v_fmamk_f32 v29, v155, 0xc1880000, v157
    v_cos_f32 v30, v29
    v_sin_f32 v31, v29
    s_nop 0
    v_cvt_pk_bf16_f32 v83, v30, -v31
    v_cvt_pk_bf16_f32 v99, v31, v30
    v_fmamk_f32 v29, v155, 0x41c00000, v156
    v_cos_f32 v30, v29
    v_sin_f32 v31, v29
    s_nop 0
    v_cvt_pk_bf16_f32 v84, v30, -v31
    v_cvt_pk_bf16_f32 v100, v31, v30
    v_fmamk_f32 v29, v155, 0xc1c00000, v157
    v_cos_f32 v30, v29
    v_sin_f32 v31, v29
    s_nop 0
    v_cvt_pk_bf16_f32 v85, v30, -v31
    v_cvt_pk_bf16_f32 v101, v31, v30
    v_fmamk_f32 v29, v155, 0x41c80000, v156
    v_cos_f32 v30, v29
    v_sin_f32 v31, v29
    s_nop 0
    v_cvt_pk_bf16_f32 v86, v30, -v31
    v_cvt_pk_bf16_f32 v102, v31, v30
    v_fmamk_f32 v29, v155, 0xc1c80000, v157
    v_cos_f32 v30, v29
    v_sin_f32 v31, v29
    s_nop 0
    v_cvt_pk_bf16_f32 v87, v30, -v31
    v_cvt_pk_bf16_f32 v103, v31, v30
    global_load_dwordx4 v[104:107], v166, s[4:5] offset:0
    global_load_dwordx4 v[108:111], v167, s[4:5] offset:0
    global_load_dwordx4 v[112:115], v6, s[8:9] offset:0 sc1
    global_load_dwordx4 v[116:119], v6, s[8:9] offset:16 sc1
    global_load_dwordx4 v[120:123], v6, s[8:9] offset:2048 sc1
    global_load_dwordx4 v[124:127], v6, s[8:9] offset:2064 sc1
    global_load_dwordx4 v[128:131], v7, s[8:9] offset:0 sc1
    global_load_dwordx4 v[132:135], v7, s[8:9] offset:16 sc1
    s_movk_i32 s57, 0x3fff
    s_waitcnt vmcnt(8)
cde_q:
    v_max3_u32 v222, v12, v13, v14
    v_max3_u32 v223, v15, v16, v17
    v_max3_u32 v222, v222, v18, v19
    v_max_u32 v222, v222, v223
    v_cmp_eq_u32 vcc, -1, v222
    s_cbranch_vccz cde_qok
    s_mov_b64 exec, vcc
    s_sleep 2
    global_load_dwordx4 v[12:15], v164, s[48:49] offset:0 sc1
    global_load_dwordx4 v[16:19], v165, s[48:49] offset:0 sc1
    s_sub_u32 s57, s57, 1
    s_waitcnt vmcnt(00)
    s_cmp_lg_u32 s57, 0
    s_cbranch_scc1 cde_q
cde_qok:
    s_mov_b64 exec, -1
    s_mov_b32 exec_lo, 0xaaaaaaaa
    s_mov_b32 exec_hi, 0xaaaaaaaa
    v_swap_b32 v12, v16
    v_swap_b32 v13, v17
    v_swap_b32 v14, v18
    v_swap_b32 v15, v19
    s_mov_b64 exec, -1
    s_nop 1
    v_mfma_f32_16x16x32_bf16 v[136:139], v[12:15], v[32:35], 0
    v_mfma_f32_16x16x32_bf16 v[140:143], v[12:15], v[40:43], 0
    v_mfma_f32_16x16x32_bf16 v[144:147], v[12:15], v[48:51], 0
    v_mfma_f32_16x16x32_bf16 v[148:151], v[12:15], v[56:59], 0
    v_mfma_f32_16x16x32_bf16 v[136:139], v[16:19], v[36:39], v[136:139]
    v_mfma_f32_16x16x32_bf16 v[140:143], v[16:19], v[44:47], v[140:143]
    v_mfma_f32_16x16x32_bf16 v[144:147], v[16:19], v[52:55], v[144:147]
    v_mfma_f32_16x16x32_bf16 v[148:151], v[16:19], v[60:63], v[148:151]
    s_mov_b64 exec, 1
    ds_add_u32 v28, v11 offset:16
    s_mov_b64 exec, -1
    s_lshr_b32 s30, s14, 4
    s_and_b32 s31, s14, 15
    s_and_b32 s22, s23, 3
    s_and_b32 s35, s31, 7
    s_mul_i32 s32, s31, 3
    s_lshl_b32 s57, s31, 1
    s_add_u32 s57, s57, 11
    s_cmp_lt_u32 s31, 11
    s_cselect_b32 s32, s32, s57
    s_cselect_b32 s33, 1, 0
    s_mul_i32 s34, s22, 11
    s_lshl_b32 s24, s22, 12
    s_lshl_b32 s15, s30, 2
    s_add_u32 s38, s15, s22
    s_mul_i32 s45, s38, 88064
    s_lshl_b32 s57, s32, 10
    s_add_u32 s45, s45, s57
    s_add_u32 s45, s45, 12582912
    s_lshl_b32 s44, s30, 11
    s_add_u32 s44, s44, 32768
    s_mov_b32 s50, 0xa9764310
    s_mov_b32 s51, 0x852
    s_cmp_eq_u32 s22, 1
    s_cselect_b32 s50, 0xa875421, s50
    s_cselect_b32 s51, 0x963, s51
    s_cmp_eq_u32 s22, 2
    s_cselect_b32 s50, 0x19865320, s50
    s_cselect_b32 s51, 0xa74, s51
    s_cmp_eq_u32 s22, 3
    s_cselect_b32 s50, 0x65430210, s50
    s_cselect_b32 s51, 0x987, s51
    v_lshlrev_b32 v5, 5, v9
    v_add_u32 v5, 110848, v5
    v_lshl_add_u32 v6, v2, 3, v5
    v_pk_mul_f32 v[152:153], v[136:137], v[64:65]
    v_pk_mul_f32 v[154:155], v[138:139], v[66:67]
    v_pk_mul_f32 v[156:157], v[140:141], v[64:65]
    v_pk_mul_f32 v[158:159], v[142:143], v[66:67]
    v_pk_fma_f32 v[152:153], v[140:141], v[68:69], v[152:153] neg_lo:[1,0,0] neg_hi:[1,0,0]
    v_pk_fma_f32 v[154:155], v[142:143], v[70:71], v[154:155] neg_lo:[1,0,0] neg_hi:[1,0,0]
    v_pk_fma_f32 v[156:157], v[136:137], v[68:69], v[156:157]
    v_pk_fma_f32 v[158:159], v[138:139], v[70:71], v[158:159]
    v_cvt_pk_bf16_f32 v20, v152, v156
    v_cvt_pk_bf16_f32 v21, v153, v157
    v_cvt_pk_bf16_f32 v22, v154, v158
    v_cvt_pk_bf16_f32 v23, v155, v159
    ds_write_b128 v4, v[20:23] offset:0
    v_pk_mul_f32 v[152:153], v[144:145], v[64:65]
    v_pk_mul_f32 v[154:155], v[146:147], v[66:67]
    v_pk_mul_f32 v[156:157], v[148:149], v[64:65]
    v_pk_mul_f32 v[158:159], v[150:151], v[66:67]
    v_pk_fma_f32 v[152:153], v[148:149], v[68:69], v[152:153] neg_lo:[1,0,0] neg_hi:[1,0,0]
    v_pk_fma_f32 v[154:155], v[150:151], v[70:71], v[154:155] neg_lo:[1,0,0] neg_hi:[1,0,0]
    v_pk_fma_f32 v[156:157], v[144:145], v[68:69], v[156:157]
    v_pk_fma_f32 v[158:159], v[146:147], v[70:71], v[158:159]
    v_cvt_pk_bf16_f32 v24, v152, v156
    v_cvt_pk_bf16_f32 v25, v153, v157
    v_cvt_pk_bf16_f32 v26, v154, v158
    v_cvt_pk_bf16_f32 v27, v155, v159
    ds_write_b128 v4, v[24:27] offset:1024
    s_mov_b64 exec, 1
    ds_add_u32 v28, v11 offset:12
    s_mov_b64 exec, -1
    s_add_u32 s36, s8, s44
    s_addc_u32 s37, s9, 0
    v_lshrrev_b32 v30, 2, v1
    v_lshlrev_b32 v30, 7, v30
    v_and_b32 v31, 3, v1
    v_lshl_add_u32 v177, v31, 4, v30
    global_load_dword v176, v177, s[36:37] offset:8 sc1
cde_s1:
    ds_read_b32 v29, v28 offset:12
    ds_read_b128 v[32:35], v10 offset:0
    ds_read_b128 v[36:39], v10 offset:1024
    ds_read_b128 v[40:43], v10 offset:2048
    ds_read_b128 v[44:47], v10 offset:3072
    ds_read_b128 v[48:51], v10 offset:4096
    ds_read_b128 v[52:55], v10 offset:5120
    ds_read_b128 v[56:59], v10 offset:6144
    ds_read_b128 v[60:63], v10 offset:7168
    s_waitcnt lgkmcnt(8)
    v_readfirstlane_b32 s15, v29
    s_nop 0
    s_cmp_ge_u32 s15, 4
    s_cbranch_scc0 cde_s1
    s_waitcnt vmcnt(7)
    s_waitcnt lgkmcnt(6)
    v_mfma_f32_16x16x32_bf16 v[136:139], v[32:35], v[72:75], 0
    v_mfma_f32_16x16x32_bf16 v[140:143], v[32:35], v[88:91], 0
    v_lshlrev_b32 v160, 16, v104
    v_and_b32 v161, 0xffff0000, v104
    v_mfma_f32_16x16x32_bf16 v[144:147], v[36:39], v[72:75], 0
    v_mfma_f32_16x16x32_bf16 v[148:151], v[36:39], v[88:91], 0
    v_lshlrev_b32 v168, 16, v108
    v_and_b32 v169, 0xffff0000, v108
    s_waitcnt lgkmcnt(4)
    v_mfma_f32_16x16x32_bf16 v[136:139], v[40:43], v[76:79], v[136:139]
    v_mfma_f32_16x16x32_bf16 v[140:143], v[40:43], v[92:95], v[140:143]
    v_lshlrev_b32 v162, 16, v105
    v_and_b32 v163, 0xffff0000, v105
    v_mfma_f32_16x16x32_bf16 v[144:147], v[44:47], v[76:79], v[144:147]
    v_mfma_f32_16x16x32_bf16 v[148:151], v[44:47], v[92:95], v[148:151]
    v_lshlrev_b32 v170, 16, v109
    v_and_b32 v171, 0xffff0000, v109
    s_waitcnt lgkmcnt(2)
    v_mfma_f32_16x16x32_bf16 v[136:139], v[48:51], v[80:83], v[136:139]
    v_mfma_f32_16x16x32_bf16 v[140:143], v[48:51], v[96:99], v[140:143]
    v_lshlrev_b32 v164, 16, v106
    v_and_b32 v165, 0xffff0000, v106
    v_mfma_f32_16x16x32_bf16 v[144:147], v[52:55], v[80:83], v[144:147]
    v_mfma_f32_16x16x32_bf16 v[148:151], v[52:55], v[96:99], v[148:151]
    v_lshlrev_b32 v172, 16, v110
    v_and_b32 v173, 0xffff0000, v110
    s_waitcnt lgkmcnt(0)
    v_mfma_f32_16x16x32_bf16 v[136:139], v[56:59], v[84:87], v[136:139]
    v_mfma_f32_16x16x32_bf16 v[140:143], v[56:59], v[100:103], v[140:143]
    v_lshlrev_b32 v166, 16, v107
    v_and_b32 v167, 0xffff0000, v107
    v_mfma_f32_16x16x32_bf16 v[144:147], v[60:63], v[84:87], v[144:147]
    v_mfma_f32_16x16x32_bf16 v[148:151], v[60:63], v[100:103], v[148:151]
    v_lshlrev_b32 v174, 16, v111
    v_and_b32 v175, 0xffff0000, v111
    v_lshlrev_b32 v7, 7, v8
    v_lshl_add_u32 v7, v9, 4, v7
    s_lshl_b32 s15, s14, 13
    s_add_u32 s15, s15, 8388608
    s_add_u32 s18, s8, s15
    s_addc_u32 s19, s9, 0
    s_waitcnt vmcnt(5)
    v_permlane16_swap_b32 v136, v140
    v_permlane16_swap_b32 v137, v141
    v_permlane16_swap_b32 v138, v142
    v_permlane16_swap_b32 v139, v143
    v_pk_fma_f32 v[160:161], v[136:137], v[112:113], v[160:161]
    v_pk_fma_f32 v[162:163], v[138:139], v[114:115], v[162:163]
    v_pk_fma_f32 v[164:165], v[140:141], v[116:117], v[164:165]
    v_pk_fma_f32 v[166:167], v[142:143], v[118:119], v[166:167]
    v_permlane16_swap_b32 v144, v148
    v_permlane16_swap_b32 v145, v149
    v_permlane16_swap_b32 v146, v150
    v_permlane16_swap_b32 v147, v151
    v_pk_fma_f32 v[168:169], v[144:145], v[112:113], v[168:169]
    v_pk_fma_f32 v[170:171], v[146:147], v[114:115], v[170:171]
    v_pk_fma_f32 v[172:173], v[148:149], v[116:117], v[172:173]
    v_pk_fma_f32 v[174:175], v[150:151], v[118:119], v[174:175]
    v_pk_add_f32 v[20:21], v[160:161], v[162:163]
    v_pk_mul_f32 v[22:23], v[160:161], v[160:161]
    v_pk_add_f32 v[24:25], v[168:169], v[170:171]
    v_pk_mul_f32 v[26:27], v[168:169], v[168:169]
    v_pk_fma_f32 v[22:23], v[162:163], v[162:163], v[22:23]
    v_pk_fma_f32 v[26:27], v[170:171], v[170:171], v[26:27]
    v_pk_add_f32 v[20:21], v[20:21], v[164:165]
    v_pk_fma_f32 v[22:23], v[164:165], v[164:165], v[22:23]
    v_pk_add_f32 v[24:25], v[24:25], v[172:173]
    v_pk_fma_f32 v[26:27], v[172:173], v[172:173], v[26:27]
    v_pk_add_f32 v[20:21], v[20:21], v[166:167]
    v_pk_fma_f32 v[22:23], v[166:167], v[166:167], v[22:23]
    v_pk_add_f32 v[24:25], v[24:25], v[174:175]
    v_pk_fma_f32 v[26:27], v[174:175], v[174:175], v[26:27]
    v_add_f32 v152, v20, v21
    v_add_f32 v153, v22, v23
    v_add_f32 v154, v24, v25
    v_add_f32 v155, v26, v27
    v_add_f32_dpp v152, v152, v152 row_ror:8 row_mask:0xf bank_mask:0xf
    v_add_f32_dpp v153, v153, v153 row_ror:8 row_mask:0xf bank_mask:0xf
    v_add_f32_dpp v154, v154, v154 row_ror:8 row_mask:0xf bank_mask:0xf
    v_add_f32_dpp v155, v155, v155 row_ror:8 row_mask:0xf bank_mask:0xf
    v_add_f32_dpp v152, v152, v152 row_ror:4 row_mask:0xf bank_mask:0xf
    v_add_f32_dpp v153, v153, v153 row_ror:4 row_mask:0xf bank_mask:0xf
    v_add_f32_dpp v154, v154, v154 row_ror:4 row_mask:0xf bank_mask:0xf
    v_add_f32_dpp v155, v155, v155 row_ror:4 row_mask:0xf bank_mask:0xf
    v_add_f32_dpp v152, v152, v152 row_ror:2 row_mask:0xf bank_mask:0xf
    v_add_f32_dpp v153, v153, v153 row_ror:2 row_mask:0xf bank_mask:0xf
    v_add_f32_dpp v154, v154, v154 row_ror:2 row_mask:0xf bank_mask:0xf
    v_add_f32_dpp v155, v155, v155 row_ror:2 row_mask:0xf bank_mask:0xf
    v_add_f32_dpp v152, v152, v152 row_ror:1 row_mask:0xf bank_mask:0xf
    v_add_f32_dpp v153, v153, v153 row_ror:1 row_mask:0xf bank_mask:0xf
    v_add_f32_dpp v154, v154, v154 row_ror:1 row_mask:0xf bank_mask:0xf
    v_add_f32_dpp v155, v155, v155 row_ror:1 row_mask:0xf bank_mask:0xf
    ds_write_b64 v6, v[152:153]
    ds_write_b64 v6, v[154:155] offset:128
    s_mov_b64 exec, 1
    ds_add_u32 v28, v11 offset:20
    s_mov_b64 exec, -1
    v_cvt_pk_bf16_f32 v224, v160, v161
    v_cvt_pk_bf16_f32 v225, v162, v163
    v_cvt_pk_bf16_f32 v226, v164, v165
    v_cvt_pk_bf16_f32 v227, v166, v167
    v_cvt_pk_bf16_f32 v228, v168, v169
    v_cvt_pk_bf16_f32 v229, v170, v171
    v_cvt_pk_bf16_f32 v230, v172, v173
    v_cvt_pk_bf16_f32 v231, v174, v175
    v_mov_b32 v32, 0x3b000000
cde_s2:
    ds_read_b32 v29, v28 offset:20
    ds_read_b128 v[48:51], v5 offset:0
    ds_read_b128 v[52:55], v5 offset:16
    ds_read_b128 v[56:59], v5 offset:128
    ds_read_b128 v[60:63], v5 offset:144
    s_waitcnt lgkmcnt(4)
    v_readfirstlane_b32 s15, v29
    s_nop 0
    s_cmp_ge_u32 s15, 4
    s_cbranch_scc0 cde_s2
    s_waitcnt lgkmcnt(0)
    s_mov_b64 exec, 1
    ds_add_u32 v28, v11 offset:48
    s_mov_b64 exec, -1
    v_pk_add_f32 v[48:49], v[48:49], v[50:51]
    v_pk_add_f32 v[52:53], v[52:53], v[54:55]
    v_pk_add_f32 v[56:57], v[56:57], v[58:59]
    v_pk_add_f32 v[60:61], v[60:61], v[62:63]
    v_pk_add_f32 v[48:49], v[48:49], v[52:53]
    v_pk_add_f32 v[56:57], v[56:57], v[60:61]
    v_pk_mul_f32 v[48:49], v[48:49], v[32:33] op_sel_hi:[1,0]
    v_pk_mul_f32 v[56:57], v[56:57], v[32:33] op_sel_hi:[1,0]
    v_fma_f32 v49, -v48, v48, v49
    v_fma_f32 v57, -v56, v56, v57
    v_max_f32 v49, 0, v49
    v_max_f32 v57, 0, v57
    v_add_f32 v49, 0x3727c5ac, v49
    v_add_f32 v57, 0x3727c5ac, v57
    v_rsq_f32 v50, v49
    v_rsq_f32 v58, v57
    s_waitcnt vmcnt(0)
    v_cmp_ne_u32 vcc, s56, v176
    s_nop 0
    s_mov_b64 s[58:59], vcc
    v_mul_f32 v52, v48, v50
    v_mul_f32 v60, v56, v58
    v_pk_fma_f32 v[160:161], v[160:161], v[50:51], v[52:53] op_sel_hi:[1,0,0] neg_lo:[0,0,1] neg_hi:[0,0,1]
    v_pk_fma_f32 v[162:163], v[162:163], v[50:51], v[52:53] op_sel_hi:[1,0,0] neg_lo:[0,0,1] neg_hi:[0,0,1]
    v_pk_fma_f32 v[164:165], v[164:165], v[50:51], v[52:53] op_sel_hi:[1,0,0] neg_lo:[0,0,1] neg_hi:[0,0,1]
    v_pk_fma_f32 v[166:167], v[166:167], v[50:51], v[52:53] op_sel_hi:[1,0,0] neg_lo:[0,0,1] neg_hi:[0,0,1]
    v_pk_fma_f32 v[160:161], v[160:161], v[128:129], v[120:121]
    v_pk_fma_f32 v[162:163], v[162:163], v[130:131], v[122:123]
    v_pk_fma_f32 v[164:165], v[164:165], v[132:133], v[124:125]
    v_pk_fma_f32 v[166:167], v[166:167], v[134:135], v[126:127]
    v_cvt_pk_bf16_f32 v20, v160, v161
    v_cvt_pk_bf16_f32 v21, v162, v163
    v_cvt_pk_bf16_f32 v22, v164, v165
    v_cvt_pk_bf16_f32 v23, v166, v167
    s_cbranch_vccnz cde_sl21
    global_store_dwordx4 v7, v[20:23], s[16:17] offset:0 nt
cde_bk22:
    v_pk_fma_f32 v[168:169], v[168:169], v[58:59], v[60:61] op_sel_hi:[1,0,0] neg_lo:[0,0,1] neg_hi:[0,0,1]
    v_pk_fma_f32 v[170:171], v[170:171], v[58:59], v[60:61] op_sel_hi:[1,0,0] neg_lo:[0,0,1] neg_hi:[0,0,1]
    v_pk_fma_f32 v[172:173], v[172:173], v[58:59], v[60:61] op_sel_hi:[1,0,0] neg_lo:[0,0,1] neg_hi:[0,0,1]
    v_pk_fma_f32 v[174:175], v[174:175], v[58:59], v[60:61] op_sel_hi:[1,0,0] neg_lo:[0,0,1] neg_hi:[0,0,1]
    v_pk_fma_f32 v[168:169], v[168:169], v[128:129], v[120:121]
    v_pk_fma_f32 v[170:171], v[170:171], v[130:131], v[122:123]
    v_pk_fma_f32 v[172:173], v[172:173], v[132:133], v[124:125]
    v_pk_fma_f32 v[174:175], v[174:175], v[134:135], v[126:127]
    v_cvt_pk_bf16_f32 v24, v168, v169
    v_cvt_pk_bf16_f32 v25, v170, v171
    v_cvt_pk_bf16_f32 v26, v172, v173
    v_cvt_pk_bf16_f32 v27, v174, v175
    s_cbranch_vccnz cde_sl23
    global_store_dwordx4 v7, v[24:27], s[16:17] offset:64 nt
cde_bk24:
    v_mov_b32 v232, v7
    s_lshl_b32 s15, s31, 7
    s_lshl_b32 s57, s22, 4
    s_add_u32 s15, s15, s57
    v_mov_b32 v5, s15
    v_mov_b32 v6, v177
    s_waitcnt vmcnt(0)
    s_mov_b64 exec, 1
    s_cbranch_vccnz cde_sl25
    global_store_dword v5, v11, s[36:37]
cde_bk26:
    s_mov_b64 exec, -1
    v_bfe_u32 v60, v1, 2, 2
    v_lshrrev_b32 v61, 5, v1
    v_bfe_u32 v62, v1, 4, 1
    v_and_b32 v63, 3, v1
    v_lshl_add_u32 v8, v61, 3, v60
    v_mul_u32_u24 v8, 192, v8
    v_lshl_add_u32 v8, v62, 5, v8
    v_lshl_add_u32 v8, v63, 3, v8
    v_add_u32 v9, 65536, v8
    v_bfe_u32 v4, v1, 3, 2
    v_lshlrev_b32 v4, 13, v4
    v_and_b32 v7, 7, v1
    v_lshl_add_u32 v4, v7, 4, v4
    v_lshl_add_u32 v4, v61, 7, v4
    s_lshl_b32 s15, s38, 15
    s_add_u32 s15, s15, 1048576
    s_add_u32 s20, s8, s15
    s_addc_u32 s21, s9, 0
    s_lshl_b32 s15, s22, 4
    s_mov_b64 s[40:41], 0xffff
    s_lshl_b64 s[40:41], s[40:41], s15
    s_lshl_b32 s15, s22, 5
    s_add_u32 s15, s15, 110656
    v_mov_b32 v52, s15
    v_mov_b32 v55, v28
    s_add_u32 s15, s24, 147456
    v_add_u32 v54, s15, v3
    v_lshl_add_u32 v56, v62, 2, v60
    v_bfe_u32 v57, v56, 1, 2
    v_lshl_add_u32 v56, v61, 4, v56
    v_lshlrev_b32 v56, 7, v56
    v_lshl_add_u32 v56, v57, 5, v56
    v_lshl_add_u32 v56, v63, 3, v56
    s_add_u32 s15, s24, 98304
    v_add_u32 v56, s15, v56
    v_xor_b32 v57, 32, v56
    v_xor_b32 v58, 64, v56
    v_xor_b32 v59, 96, v56
cde_lw27:
    ds_read_b32 v53, v55 offset:8
    s_waitcnt lgkmcnt(0)
    v_readfirstlane_b32 s15, v53
    s_nop 0
    s_cmp_ge_u32 s15, 4
    s_cbranch_scc0 cde_lw27
    ds_read_b64_tr_b16 v[16:17], v8 offset:0
    ds_read_b64_tr_b16 v[18:19], v8 offset:768
    ds_read_b64_tr_b16 v[20:21], v8 offset:64
    ds_read_b64_tr_b16 v[22:23], v8 offset:832
    ds_read_b64_tr_b16 v[24:25], v8 offset:3072
    ds_read_b64_tr_b16 v[26:27], v8 offset:3840
    ds_read_b64_tr_b16 v[28:29], v8 offset:3136
    ds_read_b64_tr_b16 v[30:31], v8 offset:3904
    ds_read_b64_tr_b16 v[32:33], v8 offset:6144
    ds_read_b64_tr_b16 v[34:35], v8 offset:6912
    ds_read_b64_tr_b16 v[36:37], v8 offset:6208
    ds_read_b64_tr_b16 v[38:39], v8 offset:6976
    v_mov_b32 v50, v6
    s_lshr_b32 s66, s31, 3
    s_lshl_b32 s67, s30, 1
    s_add_u32 s39, s67, s66
    s_mul_i32 s66, s39, 176128
    s_lshl_b32 s67, s34, 10
    s_add_u32 s66, s66, s67
    s_add_u32 s66, s66, 12582912
    s_add_u32 s10, s8, s66
    s_addc_u32 s11, s9, 0
    s_add_u32 s66, s22, 1
    s_and_b32 s66, s66, 3
    s_mul_i32 s67, s66, 44032
    v_add_u32 v60, s67, v3
    s_add_u32 s66, s22, 2
    s_and_b32 s66, s66, 3
    s_mul_i32 s67, s66, 44032
    v_add_u32 v61, s67, v3
    s_add_u32 s66, s22, 3
    s_and_b32 s66, s66, 3
    s_mul_i32 s67, s66, 44032
    v_add_u32 v62, s67, v3
    s_add_u32 s66, s22, 4
    s_and_b32 s66, s66, 3
    s_mul_i32 s67, s66, 44032
    v_add_u32 v63, s67, v3
    s_add_u32 s66, s22, 3
    s_and_b32 s66, s66, 3
    s_lshl_b32 s66, s66, 12
    s_add_u32 s66, s66, 114688
    v_add_u32 v13, s66, v3
    s_add_u32 s66, s22, 2
    s_and_b32 s66, s66, 3
    s_lshl_b32 s66, s66, 12
    s_add_u32 s66, s66, 131072
    v_add_u32 v14, s66, v3
    s_add_u32 s66, s22, 1
    s_and_b32 s66, s66, 3
    s_lshl_b32 s66, s66, 12
    s_add_u32 s66, s66, 147456
    v_add_u32 v15, s66, v3
    s_add_u32 s66, s24, 114688
    v_add_u32 v10, s66, v3
    s_lshl_b32 s16, s39, 2
    s_add_u32 s16, s16, s22
    v_and_b32 v48, 15, v1
    v_lshrrev_b32 v49, 4, v1
    s_lshl_b32 s66, s35, 8
    s_add_u32 s66, s66, 10240
    v_lshlrev_b32 v5, 4, v49
    v_add_u32 v5, s66, v5
    s_lshl_b32 s66, s16, 14
    s_lshl_b32 s67, s35, 10
    s_add_u32 s66, s66, s67
    s_add_u32 s66, s66, 8388608
    v_lshrrev_b32 v2, 3, v48
    v_lshlrev_b32 v2, 13, v2
    v_and_b32 v6, 7, v48
    v_lshl_add_u32 v2, v6, 4, v2
    v_lshrrev_b32 v6, 1, v49
    v_lshl_add_u32 v2, v6, 7, v2
    v_and_b32 v7, 1, v49
    v_lshl_add_u32 v2, v7, 3, v2
    v_add_u32 v2, s66, v2
    v_lshlrev_b32 v6, 4, v6
    v_lshl_add_u32 v6, v7, 5, v6
    v_bfe_u32 v7, v48, 1, 2
    v_lshl_add_u32 v6, v7, 19, v6
    v_lshrrev_b32 v7, 3, v48
    v_lshl_add_u32 v6, v7, 11, v6
    v_and_b32 v7, 1, v48
    v_lshl_add_u32 v6, v7, 10, v6
    s_lshl_b32 s66, s16, 12
    s_lshl_b32 s67, s35, 7
    s_add_u32 s66, s66, s67
    v_add_u32 v6, s66, v6
    s_mov_b32 s42, 0xffff
    s_mov_b32 s43, 0x0
    s_cmp_eq_u32 s22, 1
    s_cselect_b32 s42, 0xfffff000, s42
    s_cselect_b32 s43, 0x0, s43
    s_cmp_eq_u32 s22, 2
    s_cselect_b32 s42, 0xf0000000, s42
    s_cselect_b32 s43, 0xfff, s43
    s_cmp_eq_u32 s22, 3
    s_cselect_b32 s42, 0x0, s42
    s_cselect_b32 s43, 0xfffff000, s43
    s_cmp_lt_u32 s31, 8
    s_mov_b32 s67, 0xcccccccc
    s_cselect_b32 s67, 0x33333333, s67
    s_and_b32 s42, s42, s67
    s_and_b32 s43, s43, s67
    v_bfe_u32 v51, v1, 4, 1
    v_mul_u32_u24 v51, 44032, v51
    v_lshrrev_b32 v7, 5, v1
    v_lshl_add_u32 v51, v7, 8, v51
    v_lshl_add_u32 v51, v48, 4, v51
    s_add_u32 s46, s8, s45
    s_addc_u32 s47, s9, 0
    s_waitcnt lgkmcnt(0)
cde_lw28:
    ds_read_b32 v53, v52 offset:0
    s_waitcnt lgkmcnt(0)
    v_readfirstlane_b32 s15, v53
    s_nop 0
    s_cmp_ge_u32 s15, 1
    s_cbranch_scc0 cde_lw28
    ds_read_b64_tr_b16 v[240:241], v56 offset:49152
    ds_read_b64_tr_b16 v[242:243], v56 offset:50176
    ds_read_b64_tr_b16 v[244:245], v57 offset:49152
    ds_read_b64_tr_b16 v[246:247], v57 offset:50176
    ds_read_b64_tr_b16 v[248:249], v58 offset:49152
    ds_read_b64_tr_b16 v[250:251], v58 offset:50176
    ds_read_b64_tr_b16 v[252:253], v59 offset:49152
    ds_read_b64_tr_b16 v[254:255], v59 offset:50176
    s_movk_i32 s57, 0x7fff
cde_p1:
    global_load_dword v12, v50, s[36:37] sc1
    s_waitcnt vmcnt(0)
    v_cmp_ne_u32 vcc, 0, v12
    s_nop 0
    s_and_b64 s[60:61], vcc, s[40:41]
    s_cmp_eq_u64 s[60:61], s[40:41]
    s_cbranch_scc1 cde_p1_ok
    s_sub_u32 s57, s57, 1
    s_cmp_lg_u32 s57, 0
    s_cbranch_scc1 cde_p1
cde_p1_ok:
    global_load_dwordx4 v[64:67], v4, s[20:21] offset:0 sc1
    global_load_dwordx4 v[68:71], v4, s[20:21] offset:256 sc1
    global_load_dwordx4 v[72:75], v4, s[20:21] offset:512 sc1
    global_load_dwordx4 v[76:79], v4, s[20:21] offset:768 sc1
    global_load_dwordx4 v[80:83], v4, s[20:21] offset:1024 sc1
    global_load_dwordx4 v[84:87], v4, s[20:21] offset:1280 sc1
    global_load_dwordx4 v[88:91], v4, s[20:21] offset:1536 sc1
    global_load_dwordx4 v[92:95], v4, s[20:21] offset:1792 sc1
    ds_read_b64_tr_b16 v[40:41], v8 offset:9216
    ds_read_b64_tr_b16 v[42:43], v8 offset:9984
    s_waitcnt vmcnt(7)
    v_mfma_f32_32x32x16_bf16 v[192:207], v[16:19], v[64:67], 0
    ds_read_b64_tr_b16 v[44:45], v8 offset:9280
    ds_read_b64_tr_b16 v[46:47], v8 offset:10048
    v_mfma_f32_32x32x16_bf16 v[208:223], v[20:23], v[64:67], 0
    global_load_dwordx4 v[96:99], v4, s[20:21] offset:2048 sc1
    ds_read_b64_tr_b16 v[16:17], v8 offset:12288
    ds_read_b64_tr_b16 v[18:19], v8 offset:13056
    s_waitcnt vmcnt(7)
    v_mfma_f32_32x32x16_bf16 v[192:207], v[24:27], v[68:71], v[192:207]
    ds_read_b64_tr_b16 v[20:21], v8 offset:12352
    ds_read_b64_tr_b16 v[22:23], v8 offset:13120
    v_mfma_f32_32x32x16_bf16 v[208:223], v[28:31], v[68:71], v[208:223]
    global_load_dwordx4 v[100:103], v4, s[20:21] offset:2304 sc1
    ds_read_b64_tr_b16 v[24:25], v8 offset:15360
    ds_read_b64_tr_b16 v[26:27], v8 offset:16128
    s_waitcnt vmcnt(7)
    v_mfma_f32_32x32x16_bf16 v[192:207], v[32:35], v[72:75], v[192:207]
    ds_read_b64_tr_b16 v[28:29], v8 offset:15424
    ds_read_b64_tr_b16 v[30:31], v8 offset:16192
    v_mfma_f32_32x32x16_bf16 v[208:223], v[36:39], v[72:75], v[208:223]
    global_load_dwordx4 v[104:107], v4, s[20:21] offset:2560 sc1
    ds_read_b64_tr_b16 v[32:33], v8 offset:18432
    ds_read_b64_tr_b16 v[34:35], v8 offset:19200
    s_waitcnt vmcnt(7)
    s_waitcnt lgkmcnt(12)
    v_mfma_f32_32x32x16_bf16 v[192:207], v[40:43], v[76:79], v[192:207]
    ds_read_b64_tr_b16 v[36:37], v8 offset:18496
    ds_read_b64_tr_b16 v[38:39], v8 offset:19264
    s_waitcnt lgkmcnt(12)
    v_mfma_f32_32x32x16_bf16 v[208:223], v[44:47], v[76:79], v[208:223]
    global_load_dwordx4 v[108:111], v4, s[20:21] offset:2816 sc1
    ds_read_b64_tr_b16 v[40:41], v8 offset:21504
    ds_read_b64_tr_b16 v[42:43], v8 offset:22272
    s_waitcnt vmcnt(7)
    s_waitcnt lgkmcnt(12)
    v_mfma_f32_32x32x16_bf16 v[192:207], v[16:19], v[80:83], v[192:207]
    ds_read_b64_tr_b16 v[44:45], v8 offset:21568
    ds_read_b64_tr_b16 v[46:47], v8 offset:22336
    s_waitcnt lgkmcnt(12)
    v_mfma_f32_32x32x16_bf16 v[208:223], v[20:23], v[80:83], v[208:223]
    global_load_dwordx4 v[112:115], v4, s[20:21] offset:3072 sc1
    ds_read_b64_tr_b16 v[16:17], v8 offset:24576
    ds_read_b64_tr_b16 v[18:19], v8 offset:25344
    s_waitcnt vmcnt(7)
    s_waitcnt lgkmcnt(12)
    v_mfma_f32_32x32x16_bf16 v[192:207], v[24:27], v[84:87], v[192:207]
    ds_read_b64_tr_b16 v[20:21], v8 offset:24640
    ds_read_b64_tr_b16 v[22:23], v8 offset:25408
    s_waitcnt lgkmcnt(12)
    v_mfma_f32_32x32x16_bf16 v[208:223], v[28:31], v[84:87], v[208:223]
    global_load_dwordx4 v[116:119], v4, s[20:21] offset:3328 sc1
    ds_read_b64_tr_b16 v[24:25], v8 offset:27648
    ds_read_b64_tr_b16 v[26:27], v8 offset:28416
    s_waitcnt vmcnt(7)
    s_waitcnt lgkmcnt(12)
    v_mfma_f32_32x32x16_bf16 v[192:207], v[32:35], v[88:91], v[192:207]
    ds_read_b64_tr_b16 v[28:29], v8 offset:27712
    ds_read_b64_tr_b16 v[30:31], v8 offset:28480
    s_waitcnt lgkmcnt(12)
    v_mfma_f32_32x32x16_bf16 v[208:223], v[36:39], v[88:91], v[208:223]
    global_load_dwordx4 v[120:123], v4, s[20:21] offset:3584 sc1
    ds_read_b64_tr_b16 v[32:33], v8 offset:30720
    ds_read_b64_tr_b16 v[34:35], v8 offset:31488
    s_waitcnt vmcnt(7)
    s_waitcnt lgkmcnt(12)
    v_mfma_f32_32x32x16_bf16 v[192:207], v[40:43], v[92:95], v[192:207]
    ds_read_b64_tr_b16 v[36:37], v8 offset:30784
    ds_read_b64_tr_b16 v[38:39], v8 offset:31552
    s_waitcnt lgkmcnt(12)
    v_mfma_f32_32x32x16_bf16 v[208:223], v[44:47], v[92:95], v[208:223]
    global_load_dwordx4 v[124:127], v4, s[20:21] offset:3840 sc1
    ds_read_b64_tr_b16 v[40:41], v8 offset:33792
    ds_read_b64_tr_b16 v[42:43], v8 offset:34560
    s_waitcnt vmcnt(7)
    s_waitcnt lgkmcnt(12)
    v_mfma_f32_32x32x16_bf16 v[192:207], v[16:19], v[96:99], v[192:207]
    ds_read_b64_tr_b16 v[44:45], v8 offset:33856
    ds_read_b64_tr_b16 v[46:47], v8 offset:34624
    s_waitcnt lgkmcnt(12)
    v_mfma_f32_32x32x16_bf16 v[208:223], v[20:23], v[96:99], v[208:223]
    s_add_u32 s20, s20, 4096
    s_addc_u32 s21, s21, 0
    global_load_dwordx4 v[128:131], v4, s[20:21] offset:0 sc1
    ds_read_b64_tr_b16 v[16:17], v8 offset:36864
    ds_read_b64_tr_b16 v[18:19], v8 offset:37632
    s_waitcnt vmcnt(7)
    s_waitcnt lgkmcnt(12)
    v_mfma_f32_32x32x16_bf16 v[192:207], v[24:27], v[100:103], v[192:207]
    ds_read_b64_tr_b16 v[20:21], v8 offset:36928
    ds_read_b64_tr_b16 v[22:23], v8 offset:37696
    s_waitcnt lgkmcnt(12)
    v_mfma_f32_32x32x16_bf16 v[208:223], v[28:31], v[100:103], v[208:223]
    global_load_dwordx4 v[132:135], v4, s[20:21] offset:256 sc1
    ds_read_b64_tr_b16 v[24:25], v8 offset:39936
    ds_read_b64_tr_b16 v[26:27], v8 offset:40704
    s_waitcnt vmcnt(7)
    s_waitcnt lgkmcnt(12)
    v_mfma_f32_32x32x16_bf16 v[192:207], v[32:35], v[104:107], v[192:207]
    ds_read_b64_tr_b16 v[28:29], v8 offset:40000
    ds_read_b64_tr_b16 v[30:31], v8 offset:40768
    s_waitcnt lgkmcnt(12)
    v_mfma_f32_32x32x16_bf16 v[208:223], v[36:39], v[104:107], v[208:223]
    global_load_dwordx4 v[136:139], v4, s[20:21] offset:512 sc1
    ds_read_b64_tr_b16 v[32:33], v8 offset:43008
    ds_read_b64_tr_b16 v[34:35], v8 offset:43776
    s_waitcnt vmcnt(7)
    s_waitcnt lgkmcnt(12)
    v_mfma_f32_32x32x16_bf16 v[192:207], v[40:43], v[108:111], v[192:207]
    ds_read_b64_tr_b16 v[36:37], v8 offset:43072
    ds_read_b64_tr_b16 v[38:39], v8 offset:43840
    s_waitcnt lgkmcnt(12)
    v_mfma_f32_32x32x16_bf16 v[208:223], v[44:47], v[108:111], v[208:223]
    global_load_dwordx4 v[140:143], v4, s[20:21] offset:768 sc1
    ds_read_b64_tr_b16 v[40:41], v8 offset:46080
    ds_read_b64_tr_b16 v[42:43], v8 offset:46848
    s_waitcnt vmcnt(7)
    s_waitcnt lgkmcnt(12)
    v_mfma_f32_32x32x16_bf16 v[192:207], v[16:19], v[112:115], v[192:207]
    ds_read_b64_tr_b16 v[44:45], v8 offset:46144
    ds_read_b64_tr_b16 v[46:47], v8 offset:46912
    s_waitcnt lgkmcnt(12)
    v_mfma_f32_32x32x16_bf16 v[208:223], v[20:23], v[112:115], v[208:223]
    global_load_dwordx4 v[144:147], v4, s[20:21] offset:1024 sc1
    ds_read_b64_tr_b16 v[16:17], v8 offset:49152
    ds_read_b64_tr_b16 v[18:19], v8 offset:49920
    s_waitcnt vmcnt(7)
    s_waitcnt lgkmcnt(12)
    v_mfma_f32_32x32x16_bf16 v[192:207], v[24:27], v[116:119], v[192:207]
    ds_read_b64_tr_b16 v[20:21], v8 offset:49216
    ds_read_b64_tr_b16 v[22:23], v8 offset:49984
    s_waitcnt lgkmcnt(12)
    v_mfma_f32_32x32x16_bf16 v[208:223], v[28:31], v[116:119], v[208:223]
    global_load_dwordx4 v[148:151], v4, s[20:21] offset:1280 sc1
    ds_read_b64_tr_b16 v[24:25], v8 offset:52224
    ds_read_b64_tr_b16 v[26:27], v8 offset:52992
    s_waitcnt vmcnt(7)
    s_waitcnt lgkmcnt(12)
    v_mfma_f32_32x32x16_bf16 v[192:207], v[32:35], v[120:123], v[192:207]
    ds_read_b64_tr_b16 v[28:29], v8 offset:52288
    ds_read_b64_tr_b16 v[30:31], v8 offset:53056
    s_waitcnt lgkmcnt(12)
    v_mfma_f32_32x32x16_bf16 v[208:223], v[36:39], v[120:123], v[208:223]
    global_load_dwordx4 v[152:155], v4, s[20:21] offset:1536 sc1
    ds_read_b64_tr_b16 v[32:33], v8 offset:55296
    ds_read_b64_tr_b16 v[34:35], v8 offset:56064
    s_waitcnt vmcnt(7)
    s_waitcnt lgkmcnt(12)
    v_mfma_f32_32x32x16_bf16 v[192:207], v[40:43], v[124:127], v[192:207]
    ds_read_b64_tr_b16 v[36:37], v8 offset:55360
    ds_read_b64_tr_b16 v[38:39], v8 offset:56128
    s_waitcnt lgkmcnt(12)
    v_mfma_f32_32x32x16_bf16 v[208:223], v[44:47], v[124:127], v[208:223]
    global_load_dwordx4 v[156:159], v4, s[20:21] offset:1792 sc1
    ds_read_b64_tr_b16 v[40:41], v8 offset:58368
    ds_read_b64_tr_b16 v[42:43], v8 offset:59136
    s_waitcnt vmcnt(7)
    s_waitcnt lgkmcnt(12)
    v_mfma_f32_32x32x16_bf16 v[192:207], v[16:19], v[128:131], v[192:207]
    ds_read_b64_tr_b16 v[44:45], v8 offset:58432
    ds_read_b64_tr_b16 v[46:47], v8 offset:59200
    s_waitcnt lgkmcnt(12)
    v_mfma_f32_32x32x16_bf16 v[208:223], v[20:23], v[128:131], v[208:223]
    global_load_dwordx4 v[160:163], v4, s[20:21] offset:2048 sc1
    ds_read_b64_tr_b16 v[16:17], v8 offset:61440
    ds_read_b64_tr_b16 v[18:19], v8 offset:62208
    s_waitcnt vmcnt(7)
    s_waitcnt lgkmcnt(12)
    v_mfma_f32_32x32x16_bf16 v[192:207], v[24:27], v[132:135], v[192:207]
    ds_read_b64_tr_b16 v[20:21], v8 offset:61504
    ds_read_b64_tr_b16 v[22:23], v8 offset:62272
    s_waitcnt lgkmcnt(12)
    v_mfma_f32_32x32x16_bf16 v[208:223], v[28:31], v[132:135], v[208:223]
    global_load_dwordx4 v[164:167], v4, s[20:21] offset:2304 sc1
    ds_read_b64_tr_b16 v[24:25], v8 offset:64512
    ds_read_b64_tr_b16 v[26:27], v8 offset:65280
    s_waitcnt vmcnt(7)
    s_waitcnt lgkmcnt(12)
    v_mfma_f32_32x32x16_bf16 v[192:207], v[32:35], v[136:139], v[192:207]
    ds_read_b64_tr_b16 v[28:29], v8 offset:64576
    ds_read_b64_tr_b16 v[30:31], v8 offset:65344
    s_waitcnt lgkmcnt(12)
    v_mfma_f32_32x32x16_bf16 v[208:223], v[36:39], v[136:139], v[208:223]
    global_load_dwordx4 v[168:171], v4, s[20:21] offset:2560 sc1
    ds_read_b64_tr_b16 v[32:33], v9 offset:2048
    ds_read_b64_tr_b16 v[34:35], v9 offset:2816
    s_waitcnt vmcnt(7)
    s_waitcnt lgkmcnt(12)
    v_mfma_f32_32x32x16_bf16 v[192:207], v[40:43], v[140:143], v[192:207]
    ds_read_b64_tr_b16 v[36:37], v9 offset:2112
    ds_read_b64_tr_b16 v[38:39], v9 offset:2880
    s_waitcnt lgkmcnt(12)
    v_mfma_f32_32x32x16_bf16 v[208:223], v[44:47], v[140:143], v[208:223]
    global_load_dwordx4 v[172:175], v4, s[20:21] offset:2816 sc1
    ds_read_b64_tr_b16 v[40:41], v9 offset:5120
    ds_read_b64_tr_b16 v[42:43], v9 offset:5888
    s_waitcnt vmcnt(7)
    s_waitcnt lgkmcnt(12)
    v_mfma_f32_32x32x16_bf16 v[192:207], v[16:19], v[144:147], v[192:207]
    ds_read_b64_tr_b16 v[44:45], v9 offset:5184
    ds_read_b64_tr_b16 v[46:47], v9 offset:5952
    s_waitcnt lgkmcnt(12)
    v_mfma_f32_32x32x16_bf16 v[208:223], v[20:23], v[144:147], v[208:223]
    global_load_dwordx4 v[176:179], v4, s[20:21] offset:3072 sc1
    ds_read_b64_tr_b16 v[16:17], v9 offset:8192
    ds_read_b64_tr_b16 v[18:19], v9 offset:8960
    s_waitcnt vmcnt(7)
    s_waitcnt lgkmcnt(12)
    v_mfma_f32_32x32x16_bf16 v[192:207], v[24:27], v[148:151], v[192:207]
    ds_read_b64_tr_b16 v[20:21], v9 offset:8256
    ds_read_b64_tr_b16 v[22:23], v9 offset:9024
    s_waitcnt lgkmcnt(12)
    v_mfma_f32_32x32x16_bf16 v[208:223], v[28:31], v[148:151], v[208:223]
    global_load_dwordx4 v[180:183], v4, s[20:21] offset:3328 sc1
    ds_read_b64_tr_b16 v[24:25], v9 offset:11264
    ds_read_b64_tr_b16 v[26:27], v9 offset:12032
    s_waitcnt vmcnt(7)
    s_waitcnt lgkmcnt(12)
    v_mfma_f32_32x32x16_bf16 v[192:207], v[32:35], v[152:155], v[192:207]
    ds_read_b64_tr_b16 v[28:29], v9 offset:11328
    ds_read_b64_tr_b16 v[30:31], v9 offset:12096
    s_waitcnt lgkmcnt(12)
    v_mfma_f32_32x32x16_bf16 v[208:223], v[36:39], v[152:155], v[208:223]
    global_load_dwordx4 v[184:187], v4, s[20:21] offset:3584 sc1
    ds_read_b64_tr_b16 v[32:33], v9 offset:14336
    ds_read_b64_tr_b16 v[34:35], v9 offset:15104
    s_waitcnt vmcnt(7)
    s_waitcnt lgkmcnt(12)
    v_mfma_f32_32x32x16_bf16 v[192:207], v[40:43], v[156:159], v[192:207]
    ds_read_b64_tr_b16 v[36:37], v9 offset:14400
    ds_read_b64_tr_b16 v[38:39], v9 offset:15168
    s_waitcnt lgkmcnt(12)
    v_mfma_f32_32x32x16_bf16 v[208:223], v[44:47], v[156:159], v[208:223]
    global_load_dwordx4 v[188:191], v4, s[20:21] offset:3840 sc1
    ds_read_b64_tr_b16 v[40:41], v9 offset:17408
    ds_read_b64_tr_b16 v[42:43], v9 offset:18176
    s_waitcnt vmcnt(7)
    s_waitcnt lgkmcnt(12)
    v_mfma_f32_32x32x16_bf16 v[192:207], v[16:19], v[160:163], v[192:207]
    ds_read_b64_tr_b16 v[44:45], v9 offset:17472
    ds_read_b64_tr_b16 v[46:47], v9 offset:18240
    s_waitcnt lgkmcnt(12)
    v_mfma_f32_32x32x16_bf16 v[208:223], v[20:23], v[160:163], v[208:223]
    ds_read_b64_tr_b16 v[16:17], v9 offset:20480
    ds_read_b64_tr_b16 v[18:19], v9 offset:21248
    s_waitcnt vmcnt(6)
    s_waitcnt lgkmcnt(12)
    v_mfma_f32_32x32x16_bf16 v[192:207], v[24:27], v[164:167], v[192:207]
    ds_read_b64_tr_b16 v[20:21], v9 offset:20544
    ds_read_b64_tr_b16 v[22:23], v9 offset:21312
    s_waitcnt lgkmcnt(12)
    v_mfma_f32_32x32x16_bf16 v[208:223], v[28:31], v[164:167], v[208:223]
    ds_read_b64_tr_b16 v[24:25], v9 offset:23552
    ds_read_b64_tr_b16 v[26:27], v9 offset:24320
    s_waitcnt vmcnt(5)
    s_waitcnt lgkmcnt(12)
    v_mfma_f32_32x32x16_bf16 v[192:207], v[32:35], v[168:171], v[192:207]
    ds_read_b64_tr_b16 v[28:29], v9 offset:23616
    ds_read_b64_tr_b16 v[30:31], v9 offset:24384
    s_waitcnt lgkmcnt(12)
    v_mfma_f32_32x32x16_bf16 v[208:223], v[36:39], v[168:171], v[208:223]
    ds_read_b64_tr_b16 v[32:33], v9 offset:26624
    ds_read_b64_tr_b16 v[34:35], v9 offset:27392
    s_waitcnt vmcnt(4)
    s_waitcnt lgkmcnt(12)
    v_mfma_f32_32x32x16_bf16 v[192:207], v[40:43], v[172:175], v[192:207]
    ds_read_b64_tr_b16 v[36:37], v9 offset:26688
    ds_read_b64_tr_b16 v[38:39], v9 offset:27456
    s_waitcnt lgkmcnt(12)
    v_mfma_f32_32x32x16_bf16 v[208:223], v[44:47], v[172:175], v[208:223]
    ds_read_b64_tr_b16 v[40:41], v9 offset:29696
    ds_read_b64_tr_b16 v[42:43], v9 offset:30464
    s_waitcnt vmcnt(3)
    s_waitcnt lgkmcnt(12)
    v_mfma_f32_32x32x16_bf16 v[192:207], v[16:19], v[176:179], v[192:207]
    ds_read_b64_tr_b16 v[44:45], v9 offset:29760
    ds_read_b64_tr_b16 v[46:47], v9 offset:30528
    s_waitcnt lgkmcnt(12)
    v_mfma_f32_32x32x16_bf16 v[208:223], v[20:23], v[176:179], v[208:223]
    ds_read_b64_tr_b16 v[16:17], v8 offset:128
    ds_read_b64_tr_b16 v[18:19], v8 offset:896
    s_waitcnt vmcnt(2)
    s_waitcnt lgkmcnt(12)
    v_mfma_f32_32x32x16_bf16 v[192:207], v[24:27], v[180:183], v[192:207]
    global_store_dwordx4 v232, v[224:227], s[18:19] offset:0 sc1
    ds_read_b64_tr_b16 v[20:21], v8 offset:3200
    ds_read_b64_tr_b16 v[22:23], v8 offset:3968
    s_waitcnt lgkmcnt(12)
    v_mfma_f32_32x32x16_bf16 v[208:223], v[28:31], v[180:183], v[208:223]
    global_store_dwordx4 v232, v[228:231], s[18:19] offset:64 sc1
    ds_read_b64_tr_b16 v[24:25], v8 offset:6272
    ds_read_b64_tr_b16 v[26:27], v8 offset:7040
    s_waitcnt vmcnt(3)
    s_waitcnt lgkmcnt(12)
    v_mfma_f32_32x32x16_bf16 v[192:207], v[32:35], v[184:187], v[192:207]
    ds_read_b64_tr_b16 v[28:29], v8 offset:9344
    ds_read_b64_tr_b16 v[30:31], v8 offset:10112
    s_waitcnt lgkmcnt(12)
    v_mfma_f32_32x32x16_bf16 v[208:223], v[36:39], v[184:187], v[208:223]
    ds_read_b64_tr_b16 v[32:33], v8 offset:12416
    ds_read_b64_tr_b16 v[34:35], v8 offset:13184
    s_waitcnt vmcnt(2)
    s_waitcnt lgkmcnt(12)
    v_mfma_f32_32x32x16_bf16 v[192:207], v[40:43], v[188:191], v[192:207]
    s_mov_b64 exec, 1
    ds_add_u32 v52, v11 offset:24
    s_mov_b64 exec, -1
    ds_read_b64_tr_b16 v[36:37], v8 offset:15488
    ds_read_b64_tr_b16 v[38:39], v8 offset:16256
    s_waitcnt lgkmcnt(13)
    v_mfma_f32_32x32x16_bf16 v[208:223], v[44:47], v[188:191], v[208:223]
    s_cmp_eq_u32 s33, 0
    s_cbranch_scc1 cde_d2
    ds_read_b64_tr_b16 v[40:41], v8 offset:18560
    ds_read_b64_tr_b16 v[42:43], v8 offset:19328
    s_waitcnt lgkmcnt(13)
    v_mfma_f32_32x32x16_bf16 v[224:239], v[16:19], v[64:67], 0
    ds_read_b64_tr_b16 v[44:45], v8 offset:21632
    ds_read_b64_tr_b16 v[46:47], v8 offset:22400
    s_waitcnt lgkmcnt(13)
    v_mfma_f32_32x32x16_bf16 v[224:239], v[20:23], v[68:71], v[224:239]
    v_cvt_pk_bf16_f32 v192, v192, v193
    v_cvt_pk_bf16_f32 v193, v194, v195
    v_cvt_pk_bf16_f32 v194, v196, v197
    ds_read_b64_tr_b16 v[16:17], v8 offset:24704
    ds_read_b64_tr_b16 v[18:19], v8 offset:25472
    s_waitcnt lgkmcnt(13)
    v_mfma_f32_32x32x16_bf16 v[224:239], v[24:27], v[72:75], v[224:239]
    v_cvt_pk_bf16_f32 v195, v198, v199
    ds_write_b128 v54, v[192:195] offset:0
    v_cvt_pk_bf16_f32 v200, v200, v201
    ds_read_b64_tr_b16 v[20:21], v8 offset:27776
    ds_read_b64_tr_b16 v[22:23], v8 offset:28544
    s_waitcnt lgkmcnt(14)
    v_mfma_f32_32x32x16_bf16 v[224:239], v[28:31], v[76:79], v[224:239]
    v_cvt_pk_bf16_f32 v201, v202, v203
    v_cvt_pk_bf16_f32 v202, v204, v205
    v_cvt_pk_bf16_f32 v203, v206, v207
    ds_read_b64_tr_b16 v[24:25], v8 offset:30848
    ds_read_b64_tr_b16 v[26:27], v8 offset:31616
    s_waitcnt lgkmcnt(14)
    v_mfma_f32_32x32x16_bf16 v[224:239], v[32:35], v[80:83], v[224:239]
    ds_write_b128 v54, v[200:203] offset:1024
    s_mov_b64 exec, 1
    ds_add_u32 v52, v11 offset:4
    s_mov_b64 exec, -1
    v_exp_f32 v192, v208
    ds_read_b64_tr_b16 v[28:29], v8 offset:33920
    ds_read_b64_tr_b16 v[30:31], v8 offset:34688
    s_waitcnt lgkmcnt(15)
    v_mfma_f32_32x32x16_bf16 v[224:239], v[36:39], v[84:87], v[224:239]
    v_exp_f32 v193, v209
    v_exp_f32 v194, v210
    v_exp_f32 v195, v211
    ds_read_b64_tr_b16 v[32:33], v8 offset:36992
    ds_read_b64_tr_b16 v[34:35], v8 offset:37760
    s_waitcnt lgkmcnt(15)
    v_mfma_f32_32x32x16_bf16 v[224:239], v[40:43], v[88:91], v[224:239]
    v_exp_f32 v196, v212
    v_exp_f32 v197, v213
    v_exp_f32 v198, v214
    ds_read_b64_tr_b16 v[36:37], v8 offset:40064
    ds_read_b64_tr_b16 v[38:39], v8 offset:40832
    s_waitcnt lgkmcnt(15)
    v_mfma_f32_32x32x16_bf16 v[224:239], v[44:47], v[92:95], v[224:239]
    v_exp_f32 v199, v215
    v_pk_add_f32 v[192:193], v[192:193], 1.0 op_sel_hi:[1,0]
    v_pk_add_f32 v[194:195], v[194:195], 1.0 op_sel_hi:[1,0]
    ds_read_b64_tr_b16 v[40:41], v8 offset:43136
    ds_read_b64_tr_b16 v[42:43], v8 offset:43904
    s_waitcnt lgkmcnt(15)
    v_mfma_f32_32x32x16_bf16 v[224:239], v[16:19], v[96:99], v[224:239]
    v_pk_add_f32 v[196:197], v[196:197], 1.0 op_sel_hi:[1,0]
    v_pk_add_f32 v[198:199], v[198:199], 1.0 op_sel_hi:[1,0]
    v_rcp_f32 v192, v192
    ds_read_b64_tr_b16 v[44:45], v8 offset:46208
    ds_read_b64_tr_b16 v[46:47], v8 offset:46976
    s_waitcnt lgkmcnt(14)
    v_mfma_f32_32x32x16_bf16 v[224:239], v[20:23], v[100:103], v[224:239]
    v_rcp_f32 v193, v193
    v_rcp_f32 v194, v194
    v_rcp_f32 v195, v195
    ds_read_b64_tr_b16 v[16:17], v8 offset:49280
    ds_read_b64_tr_b16 v[18:19], v8 offset:50048
    s_waitcnt lgkmcnt(14)
    v_mfma_f32_32x32x16_bf16 v[224:239], v[24:27], v[104:107], v[224:239]
    v_rcp_f32 v196, v196
    v_rcp_f32 v197, v197
    v_rcp_f32 v198, v198
    ds_read_b64_tr_b16 v[20:21], v8 offset:52352
    ds_read_b64_tr_b16 v[22:23], v8 offset:53120
    s_waitcnt lgkmcnt(12)
    v_mfma_f32_32x32x16_bf16 v[224:239], v[28:31], v[108:111], v[224:239]
    v_rcp_f32 v199, v199
    v_pk_mul_f32 v[208:209], v[208:209], v[192:193]
    v_pk_mul_f32 v[210:211], v[210:211], v[194:195]
    ds_read_b64_tr_b16 v[24:25], v8 offset:55424
    ds_read_b64_tr_b16 v[26:27], v8 offset:56192
    s_waitcnt lgkmcnt(12)
    v_mfma_f32_32x32x16_bf16 v[224:239], v[32:35], v[112:115], v[224:239]
    v_pk_mul_f32 v[212:213], v[212:213], v[196:197]
    v_pk_mul_f32 v[214:215], v[214:215], v[198:199]
    v_cvt_pk_bf16_f32 v208, v208, v209
    ds_read_b64_tr_b16 v[28:29], v8 offset:58496
    ds_read_b64_tr_b16 v[30:31], v8 offset:59264
    s_waitcnt lgkmcnt(12)
    v_mfma_f32_32x32x16_bf16 v[224:239], v[36:39], v[116:119], v[224:239]
    v_cvt_pk_bf16_f32 v209, v210, v211
    v_cvt_pk_bf16_f32 v210, v212, v213
    v_cvt_pk_bf16_f32 v211, v214, v215
    ds_read_b64_tr_b16 v[32:33], v8 offset:61568
    ds_read_b64_tr_b16 v[34:35], v8 offset:62336
    s_waitcnt lgkmcnt(12)
    v_mfma_f32_32x32x16_bf16 v[224:239], v[40:43], v[120:123], v[224:239]
    global_store_dwordx4 v51, v[208:211], s[46:47] offset:1024 sc1
    v_exp_f32 v200, v216
    v_exp_f32 v201, v217
    ds_read_b64_tr_b16 v[36:37], v8 offset:64640
    ds_read_b64_tr_b16 v[38:39], v8 offset:65408
    s_waitcnt lgkmcnt(12)
    v_mfma_f32_32x32x16_bf16 v[224:239], v[44:47], v[124:127], v[224:239]
    v_exp_f32 v202, v218
    v_exp_f32 v203, v219
    v_exp_f32 v204, v220
    ds_read_b64_tr_b16 v[40:41], v9 offset:2176
    ds_read_b64_tr_b16 v[42:43], v9 offset:2944
    s_waitcnt lgkmcnt(12)
    v_mfma_f32_32x32x16_bf16 v[224:239], v[16:19], v[128:131], v[224:239]
    v_exp_f32 v205, v221
    v_exp_f32 v206, v222
    v_exp_f32 v207, v223
    ds_read_b64_tr_b16 v[44:45], v9 offset:5248
    ds_read_b64_tr_b16 v[46:47], v9 offset:6016
    s_waitcnt lgkmcnt(12)
    v_mfma_f32_32x32x16_bf16 v[224:239], v[20:23], v[132:135], v[224:239]
    v_pk_add_f32 v[200:201], v[200:201], 1.0 op_sel_hi:[1,0]
    v_pk_add_f32 v[202:203], v[202:203], 1.0 op_sel_hi:[1,0]
    v_pk_add_f32 v[204:205], v[204:205], 1.0 op_sel_hi:[1,0]
    ds_read_b64_tr_b16 v[16:17], v9 offset:8320
    ds_read_b64_tr_b16 v[18:19], v9 offset:9088
    s_waitcnt lgkmcnt(12)
    v_mfma_f32_32x32x16_bf16 v[224:239], v[24:27], v[136:139], v[224:239]
    v_pk_add_f32 v[206:207], v[206:207], 1.0 op_sel_hi:[1,0]
    v_rcp_f32 v200, v200
    v_rcp_f32 v201, v201
    ds_read_b64_tr_b16 v[20:21], v9 offset:11392
    ds_read_b64_tr_b16 v[22:23], v9 offset:12160
    s_waitcnt lgkmcnt(12)
    v_mfma_f32_32x32x16_bf16 v[224:239], v[28:31], v[140:143], v[224:239]
    v_rcp_f32 v202, v202
    v_rcp_f32 v203, v203
    v_rcp_f32 v204, v204
    ds_read_b64_tr_b16 v[24:25], v9 offset:14464
    ds_read_b64_tr_b16 v[26:27], v9 offset:15232
    s_waitcnt lgkmcnt(12)
    v_mfma_f32_32x32x16_bf16 v[224:239], v[32:35], v[144:147], v[224:239]
    v_rcp_f32 v205, v205
    v_rcp_f32 v206, v206
    v_rcp_f32 v207, v207
    ds_read_b64_tr_b16 v[28:29], v9 offset:17536
    ds_read_b64_tr_b16 v[30:31], v9 offset:18304
    s_waitcnt lgkmcnt(12)
    v_mfma_f32_32x32x16_bf16 v[224:239], v[36:39], v[148:151], v[224:239]
    v_pk_mul_f32 v[216:217], v[216:217], v[200:201]
    v_pk_mul_f32 v[218:219], v[218:219], v[202:203]
    v_pk_mul_f32 v[220:221], v[220:221], v[204:205]
    ds_read_b64_tr_b16 v[32:33], v9 offset:20608
    ds_read_b64_tr_b16 v[34:35], v9 offset:21376
    s_waitcnt lgkmcnt(12)
    v_mfma_f32_32x32x16_bf16 v[224:239], v[40:43], v[152:155], v[224:239]
    v_pk_mul_f32 v[222:223], v[222:223], v[206:207]
    v_cvt_pk_bf16_f32 v216, v216, v217
    v_cvt_pk_bf16_f32 v217, v218, v219
    ds_read_b64_tr_b16 v[36:37], v9 offset:23680
    ds_read_b64_tr_b16 v[38:39], v9 offset:24448
    s_waitcnt lgkmcnt(12)
    v_mfma_f32_32x32x16_bf16 v[224:239], v[44:47], v[156:159], v[224:239]
    v_cvt_pk_bf16_f32 v218, v220, v221
    v_cvt_pk_bf16_f32 v219, v222, v223
    global_store_dwordx4 v51, v[216:219], s[46:47] offset:1536 sc1
    ds_read_b64_tr_b16 v[40:41], v9 offset:26752
    ds_read_b64_tr_b16 v[42:43], v9 offset:27520
    s_waitcnt lgkmcnt(12)
    v_mfma_f32_32x32x16_bf16 v[224:239], v[16:19], v[160:163], v[224:239]
    ds_read_b64_tr_b16 v[44:45], v9 offset:29824
    ds_read_b64_tr_b16 v[46:47], v9 offset:30592
    s_waitcnt lgkmcnt(12)
    v_mfma_f32_32x32x16_bf16 v[224:239], v[20:23], v[164:167], v[224:239]
    s_waitcnt lgkmcnt(10)
    v_mfma_f32_32x32x16_bf16 v[224:239], v[24:27], v[168:171], v[224:239]
    s_waitcnt lgkmcnt(8)
    v_mfma_f32_32x32x16_bf16 v[224:239], v[28:31], v[172:175], v[224:239]
    s_waitcnt lgkmcnt(6)
    v_mfma_f32_32x32x16_bf16 v[224:239], v[32:35], v[176:179], v[224:239]
    s_waitcnt lgkmcnt(4)
    v_mfma_f32_32x32x16_bf16 v[224:239], v[36:39], v[180:183], v[224:239]
    s_waitcnt lgkmcnt(2)
    v_mfma_f32_32x32x16_bf16 v[224:239], v[40:43], v[184:187], v[224:239]
    s_waitcnt lgkmcnt(0)
    v_mfma_f32_32x32x16_bf16 v[224:239], v[44:47], v[188:191], v[224:239]
    s_nop 11
    v_cvt_pk_bf16_f32 v224, v224, v225
    v_cvt_pk_bf16_f32 v225, v226, v227
    v_cvt_pk_bf16_f32 v226, v228, v229
    v_cvt_pk_bf16_f32 v227, v230, v231
    ds_write_b128 v54, v[224:227] offset:2048
    v_cvt_pk_bf16_f32 v232, v232, v233
    v_cvt_pk_bf16_f32 v233, v234, v235
    v_cvt_pk_bf16_f32 v234, v236, v237
    v_cvt_pk_bf16_f32 v235, v238, v239
    ds_write_b128 v54, v[232:235] offset:3072
    s_mov_b64 exec, 1
    ds_add_u32 v52, v11 offset:4
    s_mov_b64 exec, -1
    s_branch cde_d3
cde_d2:
    s_nop 2
    v_cvt_pk_bf16_f32 v192, v192, v193
    v_cvt_pk_bf16_f32 v193, v194, v195
    v_cvt_pk_bf16_f32 v194, v196, v197
    v_cvt_pk_bf16_f32 v195, v198, v199
    ds_write_b128 v54, v[192:195] offset:0
    v_cvt_pk_bf16_f32 v200, v200, v201
    v_cvt_pk_bf16_f32 v201, v202, v203
    v_cvt_pk_bf16_f32 v202, v204, v205
    v_cvt_pk_bf16_f32 v203, v206, v207
    ds_write_b128 v54, v[200:203] offset:1024
    s_mov_b64 exec, 1
    ds_add_u32 v52, v11 offset:4
    s_mov_b64 exec, -1
    v_exp_f32 v192, v208
    v_exp_f32 v193, v209
    v_exp_f32 v194, v210
    v_exp_f32 v195, v211
    v_exp_f32 v196, v212
    v_exp_f32 v197, v213
    v_exp_f32 v198, v214
    v_exp_f32 v199, v215
    v_pk_add_f32 v[192:193], v[192:193], 1.0 op_sel_hi:[1,0]
    v_pk_add_f32 v[194:195], v[194:195], 1.0 op_sel_hi:[1,0]
    v_pk_add_f32 v[196:197], v[196:197], 1.0 op_sel_hi:[1,0]
    v_pk_add_f32 v[198:199], v[198:199], 1.0 op_sel_hi:[1,0]
    v_rcp_f32 v192, v192
    v_rcp_f32 v193, v193
    v_rcp_f32 v194, v194
    v_rcp_f32 v195, v195
    v_rcp_f32 v196, v196
    v_rcp_f32 v197, v197
    v_rcp_f32 v198, v198
    v_rcp_f32 v199, v199
    v_pk_mul_f32 v[208:209], v[208:209], v[192:193]
    v_pk_mul_f32 v[210:211], v[210:211], v[194:195]
    v_pk_mul_f32 v[212:213], v[212:213], v[196:197]
    v_pk_mul_f32 v[214:215], v[214:215], v[198:199]
    v_cvt_pk_bf16_f32 v208, v208, v209
    v_cvt_pk_bf16_f32 v209, v210, v211
    v_cvt_pk_bf16_f32 v210, v212, v213
    v_cvt_pk_bf16_f32 v211, v214, v215
    global_store_dwordx4 v51, v[208:211], s[46:47] offset:1024 sc1
    v_exp_f32 v200, v216
    v_exp_f32 v201, v217
    v_exp_f32 v202, v218
    v_exp_f32 v203, v219
    v_exp_f32 v204, v220
    v_exp_f32 v205, v221
    v_exp_f32 v206, v222
    v_exp_f32 v207, v223
    v_pk_add_f32 v[200:201], v[200:201], 1.0 op_sel_hi:[1,0]
    v_pk_add_f32 v[202:203], v[202:203], 1.0 op_sel_hi:[1,0]
    v_pk_add_f32 v[204:205], v[204:205], 1.0 op_sel_hi:[1,0]
    v_pk_add_f32 v[206:207], v[206:207], 1.0 op_sel_hi:[1,0]
    v_rcp_f32 v200, v200
    v_rcp_f32 v201, v201
    v_rcp_f32 v202, v202
    v_rcp_f32 v203, v203
    v_rcp_f32 v204, v204
    v_rcp_f32 v205, v205
    v_rcp_f32 v206, v206
    v_rcp_f32 v207, v207
    v_pk_mul_f32 v[216:217], v[216:217], v[200:201]
    v_pk_mul_f32 v[218:219], v[218:219], v[202:203]
    v_pk_mul_f32 v[220:221], v[220:221], v[204:205]
    v_pk_mul_f32 v[222:223], v[222:223], v[206:207]
    v_cvt_pk_bf16_f32 v216, v216, v217
    v_cvt_pk_bf16_f32 v217, v218, v219
    v_cvt_pk_bf16_f32 v218, v220, v221
    v_cvt_pk_bf16_f32 v219, v222, v223
    global_store_dwordx4 v51, v[216:219], s[46:47] offset:1536 sc1
cde_d3:
    s_mov_b64 exec, 1
    ds_add_u32 v55, v11 offset:52
    s_mov_b64 exec, -1
    s_mov_b64 vcc, s[58:59]
    v_mov_b32 v12, 2
    s_lshl_b32 s15, s31, 7
    s_lshl_b32 s57, s22, 4
    s_add_u32 s15, s15, s57
    v_mov_b32 v53, s15
    s_waitcnt vmcnt(0)
    s_mov_b64 exec, 1
    s_cbranch_vccnz cde_sl29
    global_store_dword v53, v12, s[36:37]
cde_bk30:
    s_mov_b64 exec, -1
    s_movk_i32 s57, 0x7fff
cde_p2:
    global_load_dwordx2 v[8:9], v50, s[36:37] sc1
    s_waitcnt vmcnt(0)
    v_mul_u32_u24 v8, v8, v9
    v_cmp_eq_u32 vcc, 2, v8
    s_nop 0
    s_and_b64 s[40:41], vcc, s[42:43]
    s_cmp_eq_u64 s[40:41], s[42:43]
    s_cbranch_scc1 cde_p2_ok
    s_sub_u32 s57, s57, 1
    s_cmp_lg_u32 s57, 0
    s_cbranch_scc1 cde_p2
cde_p2_ok:
    s_bfe_u32 s57, s50, 0x40000
    s_lshl_b32 s57, s57, 10
    s_add_u32 s12, s10, s57
    s_addc_u32 s13, s11, 0
    global_load_dwordx4 v[64:67], v60, s[12:13] offset:0 sc1
    global_load_dwordx4 v[68:71], v61, s[12:13] offset:0 sc1
    global_load_dwordx4 v[72:75], v62, s[12:13] offset:0 sc1
    global_load_dwordx4 v[76:79], v63, s[12:13] offset:0 sc1
    s_bfe_u32 s57, s50, 0x40004
    s_lshl_b32 s57, s57, 10
    s_add_u32 s12, s10, s57
    s_addc_u32 s13, s11, 0
    global_load_dwordx4 v[80:83], v60, s[12:13] offset:0 sc1
    global_load_dwordx4 v[84:87], v61, s[12:13] offset:0 sc1
    global_load_dwordx4 v[88:91], v62, s[12:13] offset:0 sc1
    global_load_dwordx4 v[92:95], v63, s[12:13] offset:0 sc1
    s_bfe_u32 s57, s50, 0x40008
    s_lshl_b32 s57, s57, 10
    s_add_u32 s12, s10, s57
    s_addc_u32 s13, s11, 0
    global_load_dwordx4 v[96:99], v60, s[12:13] offset:0 sc1
    global_load_dwordx4 v[100:103], v61, s[12:13] offset:0 sc1
    global_load_dwordx4 v[104:107], v62, s[12:13] offset:0 sc1
    global_load_dwordx4 v[108:111], v63, s[12:13] offset:0 sc1
    s_waitcnt vmcnt(8)
    s_waitcnt lgkmcnt(0)
    ds_read_b64_tr_b16 v[32:33], v56 offset:16384
    ds_read_b64_tr_b16 v[34:35], v56 offset:17408
    ds_read_b64_tr_b16 v[36:37], v57 offset:16384
    ds_read_b64_tr_b16 v[38:39], v57 offset:17408
    ds_read_b64_tr_b16 v[40:41], v58 offset:16384
    ds_read_b64_tr_b16 v[42:43], v58 offset:17408
    ds_read_b64_tr_b16 v[44:45], v59 offset:16384
    ds_read_b64_tr_b16 v[46:47], v59 offset:17408
    s_cmp_lt_u32 s22, 3
    s_cbranch_scc0 cde_no1
    s_bfe_u32 s57, s50, 0x4000c
    s_lshl_b32 s57, s57, 10
    s_add_u32 s12, s10, s57
    s_addc_u32 s13, s11, 0
    global_load_dwordx4 v[112:115], v60, s[12:13] offset:0 sc1
    global_load_dwordx4 v[116:119], v61, s[12:13] offset:0 sc1
    global_load_dwordx4 v[120:123], v62, s[12:13] offset:0 sc1
    global_load_dwordx4 v[124:127], v63, s[12:13] offset:0 sc1
cde_no1:
    v_mfma_f32_16x16x32_bf16 v[176:179], v[240:243], v[64:67], 0
    v_mfma_f32_16x16x32_bf16 v[180:183], v[244:247], v[64:67], 0
    v_mfma_f32_16x16x32_bf16 v[184:187], v[248:251], v[64:67], 0
    v_mfma_f32_16x16x32_bf16 v[188:191], v[252:255], v[64:67], 0
    v_mfma_f32_16x16x32_bf16 v[192:195], v[240:243], v[68:71], 0
    v_mfma_f32_16x16x32_bf16 v[196:199], v[244:247], v[68:71], 0
    v_mfma_f32_16x16x32_bf16 v[200:203], v[248:251], v[68:71], 0
    v_mfma_f32_16x16x32_bf16 v[204:207], v[252:255], v[68:71], 0
    v_mfma_f32_16x16x32_bf16 v[208:211], v[240:243], v[72:75], 0
    v_mfma_f32_16x16x32_bf16 v[212:215], v[244:247], v[72:75], 0
    v_mfma_f32_16x16x32_bf16 v[216:219], v[248:251], v[72:75], 0
    v_mfma_f32_16x16x32_bf16 v[220:223], v[252:255], v[72:75], 0
    v_mfma_f32_16x16x32_bf16 v[224:227], v[240:243], v[76:79], 0
    v_mfma_f32_16x16x32_bf16 v[228:231], v[244:247], v[76:79], 0
    v_mfma_f32_16x16x32_bf16 v[232:235], v[248:251], v[76:79], 0
    v_mfma_f32_16x16x32_bf16 v[236:239], v[252:255], v[76:79], 0
    s_waitcnt vmcnt(4)
    s_waitcnt lgkmcnt(0)
    ds_read_b64_tr_b16 v[16:17], v56 offset:32768
    ds_read_b64_tr_b16 v[18:19], v56 offset:33792
    ds_read_b64_tr_b16 v[20:21], v57 offset:32768
    ds_read_b64_tr_b16 v[22:23], v57 offset:33792
    ds_read_b64_tr_b16 v[24:25], v58 offset:32768
    ds_read_b64_tr_b16 v[26:27], v58 offset:33792
    ds_read_b64_tr_b16 v[28:29], v59 offset:32768
    ds_read_b64_tr_b16 v[30:31], v59 offset:33792
    v_mfma_f32_16x16x32_bf16 v[176:179], v[32:35], v[80:83], v[176:179]
    v_mfma_f32_16x16x32_bf16 v[180:183], v[36:39], v[80:83], v[180:183]
    s_bfe_u32 s57, s50, 0x40010
    s_lshl_b32 s57, s57, 10
    s_add_u32 s12, s10, s57
    s_addc_u32 s13, s11, 0
    global_load_dwordx4 v[128:131], v60, s[12:13] offset:0 sc1
    v_mfma_f32_16x16x32_bf16 v[184:187], v[40:43], v[80:83], v[184:187]
    v_mfma_f32_16x16x32_bf16 v[188:191], v[44:47], v[80:83], v[188:191]
    v_mfma_f32_16x16x32_bf16 v[192:195], v[32:35], v[84:87], v[192:195]
    v_mfma_f32_16x16x32_bf16 v[196:199], v[36:39], v[84:87], v[196:199]
    global_load_dwordx4 v[132:135], v61, s[12:13] offset:0 sc1
    v_mfma_f32_16x16x32_bf16 v[200:203], v[40:43], v[84:87], v[200:203]
    v_mfma_f32_16x16x32_bf16 v[204:207], v[44:47], v[84:87], v[204:207]
    v_mfma_f32_16x16x32_bf16 v[208:211], v[32:35], v[88:91], v[208:211]
    v_mfma_f32_16x16x32_bf16 v[212:215], v[36:39], v[88:91], v[212:215]
    global_load_dwordx4 v[136:139], v62, s[12:13] offset:0 sc1
    v_mfma_f32_16x16x32_bf16 v[216:219], v[40:43], v[88:91], v[216:219]
    v_mfma_f32_16x16x32_bf16 v[220:223], v[44:47], v[88:91], v[220:223]
    v_mfma_f32_16x16x32_bf16 v[224:227], v[32:35], v[92:95], v[224:227]
    v_mfma_f32_16x16x32_bf16 v[228:231], v[36:39], v[92:95], v[228:231]
    global_load_dwordx4 v[140:143], v63, s[12:13] offset:0 sc1
    v_mfma_f32_16x16x32_bf16 v[232:235], v[40:43], v[92:95], v[232:235]
    v_mfma_f32_16x16x32_bf16 v[236:239], v[44:47], v[92:95], v[236:239]
    s_waitcnt vmcnt(4)
    s_waitcnt lgkmcnt(0)
    ds_read_b64_tr_b16 v[32:33], v56 offset:0
    ds_read_b64_tr_b16 v[34:35], v56 offset:1024
    ds_read_b64_tr_b16 v[36:37], v57 offset:0
    ds_read_b64_tr_b16 v[38:39], v57 offset:1024
    ds_read_b64_tr_b16 v[40:41], v58 offset:0
    ds_read_b64_tr_b16 v[42:43], v58 offset:1024
    ds_read_b64_tr_b16 v[44:45], v59 offset:0
    ds_read_b64_tr_b16 v[46:47], v59 offset:1024
    v_mfma_f32_16x16x32_bf16 v[176:179], v[16:19], v[96:99], v[176:179]
    v_mfma_f32_16x16x32_bf16 v[180:183], v[20:23], v[96:99], v[180:183]
    s_bfe_u32 s57, s50, 0x40014
    s_lshl_b32 s57, s57, 10
    s_add_u32 s12, s10, s57
    s_addc_u32 s13, s11, 0
    global_load_dwordx4 v[144:147], v60, s[12:13] offset:0 sc1
    v_mfma_f32_16x16x32_bf16 v[184:187], v[24:27], v[96:99], v[184:187]
    v_mfma_f32_16x16x32_bf16 v[188:191], v[28:31], v[96:99], v[188:191]
    v_mfma_f32_16x16x32_bf16 v[192:195], v[16:19], v[100:103], v[192:195]
    v_mfma_f32_16x16x32_bf16 v[196:199], v[20:23], v[100:103], v[196:199]
    global_load_dwordx4 v[148:151], v61, s[12:13] offset:0 sc1
    v_mfma_f32_16x16x32_bf16 v[200:203], v[24:27], v[100:103], v[200:203]
    v_mfma_f32_16x16x32_bf16 v[204:207], v[28:31], v[100:103], v[204:207]
    v_mfma_f32_16x16x32_bf16 v[208:211], v[16:19], v[104:107], v[208:211]
    v_mfma_f32_16x16x32_bf16 v[212:215], v[20:23], v[104:107], v[212:215]
    global_load_dwordx4 v[152:155], v62, s[12:13] offset:0 sc1
    v_mfma_f32_16x16x32_bf16 v[216:219], v[24:27], v[104:107], v[216:219]
    v_mfma_f32_16x16x32_bf16 v[220:223], v[28:31], v[104:107], v[220:223]
    v_mfma_f32_16x16x32_bf16 v[224:227], v[16:19], v[108:111], v[224:227]
    v_mfma_f32_16x16x32_bf16 v[228:231], v[20:23], v[108:111], v[228:231]
    global_load_dwordx4 v[156:159], v63, s[12:13] offset:0 sc1
    v_mfma_f32_16x16x32_bf16 v[232:235], v[24:27], v[108:111], v[232:235]
    v_mfma_f32_16x16x32_bf16 v[236:239], v[28:31], v[108:111], v[236:239]
    s_waitcnt vmcnt(7)
    s_waitcnt lgkmcnt(0)
cde_lw31:
    ds_read_b32 v53, v52 offset:16
    s_waitcnt lgkmcnt(0)
    v_readfirstlane_b32 s15, v53
    s_nop 0
    s_cmp_ge_u32 s15, 1
    s_cbranch_scc0 cde_lw31
    ds_read_b64_tr_b16 v[16:17], v56 offset:49152
    ds_read_b64_tr_b16 v[18:19], v56 offset:50176
    ds_read_b64_tr_b16 v[20:21], v57 offset:49152
    ds_read_b64_tr_b16 v[22:23], v57 offset:50176
    ds_read_b64_tr_b16 v[24:25], v58 offset:49152
    ds_read_b64_tr_b16 v[26:27], v58 offset:50176
    ds_read_b64_tr_b16 v[28:29], v59 offset:49152
    ds_read_b64_tr_b16 v[30:31], v59 offset:50176
    s_bfe_u32 s57, s50, 0x40018
    s_lshl_b32 s57, s57, 10
    s_add_u32 s12, s10, s57
    s_addc_u32 s13, s11, 0
    global_load_dwordx4 v[160:163], v60, s[12:13] offset:0 sc1
    global_load_dwordx4 v[164:167], v61, s[12:13] offset:0 sc1
    global_load_dwordx4 v[168:171], v62, s[12:13] offset:0 sc1
    global_load_dwordx4 v[172:175], v63, s[12:13] offset:0 sc1
    s_cmp_lt_u32 s22, 3
    s_cbranch_scc0 cde_no2
    v_mfma_f32_16x16x32_bf16 v[176:179], v[32:35], v[112:115], v[176:179]
    v_mfma_f32_16x16x32_bf16 v[180:183], v[36:39], v[112:115], v[180:183]
    v_mfma_f32_16x16x32_bf16 v[184:187], v[40:43], v[112:115], v[184:187]
    v_mfma_f32_16x16x32_bf16 v[188:191], v[44:47], v[112:115], v[188:191]
    v_mfma_f32_16x16x32_bf16 v[192:195], v[32:35], v[116:119], v[192:195]
    v_mfma_f32_16x16x32_bf16 v[196:199], v[36:39], v[116:119], v[196:199]
    v_mfma_f32_16x16x32_bf16 v[200:203], v[40:43], v[116:119], v[200:203]
    v_mfma_f32_16x16x32_bf16 v[204:207], v[44:47], v[116:119], v[204:207]
    v_mfma_f32_16x16x32_bf16 v[208:211], v[32:35], v[120:123], v[208:211]
    v_mfma_f32_16x16x32_bf16 v[212:215], v[36:39], v[120:123], v[212:215]
    v_mfma_f32_16x16x32_bf16 v[216:219], v[40:43], v[120:123], v[216:219]
    v_mfma_f32_16x16x32_bf16 v[220:223], v[44:47], v[120:123], v[220:223]
    v_mfma_f32_16x16x32_bf16 v[224:227], v[32:35], v[124:127], v[224:227]
    v_mfma_f32_16x16x32_bf16 v[228:231], v[36:39], v[124:127], v[228:231]
    v_mfma_f32_16x16x32_bf16 v[232:235], v[40:43], v[124:127], v[232:235]
    v_mfma_f32_16x16x32_bf16 v[236:239], v[44:47], v[124:127], v[236:239]
cde_no2:
    s_waitcnt vmcnt(8)
    s_waitcnt lgkmcnt(0)
cde_lw32:
    ds_read_b32 v53, v52 offset:20
    s_waitcnt lgkmcnt(0)
    v_readfirstlane_b32 s15, v53
    s_nop 0
    s_cmp_ge_u32 s15, 1
    s_cbranch_scc0 cde_lw32
    v_add_u32 v56, 0xfffe8000, v56
    v_add_u32 v57, 0xfffe8000, v57
    v_add_u32 v58, 0xfffe8000, v58
    v_add_u32 v59, 0xfffe8000, v59
    ds_read_b64_tr_b16 v[32:33], v56 offset:0
    ds_read_b64_tr_b16 v[34:35], v56 offset:1024
    ds_read_b64_tr_b16 v[36:37], v57 offset:0
    ds_read_b64_tr_b16 v[38:39], v57 offset:1024
    ds_read_b64_tr_b16 v[40:41], v58 offset:0
    ds_read_b64_tr_b16 v[42:43], v58 offset:1024
    ds_read_b64_tr_b16 v[44:45], v59 offset:0
    ds_read_b64_tr_b16 v[46:47], v59 offset:1024
    v_mfma_f32_16x16x32_bf16 v[176:179], v[16:19], v[128:131], v[176:179]
    v_mfma_f32_16x16x32_bf16 v[180:183], v[20:23], v[128:131], v[180:183]
    s_bfe_u32 s57, s50, 0x4001c
    s_lshl_b32 s57, s57, 10
    s_add_u32 s12, s10, s57
    s_addc_u32 s13, s11, 0
    global_load_dwordx4 v[64:67], v60, s[12:13] offset:0 sc1
    v_mfma_f32_16x16x32_bf16 v[184:187], v[24:27], v[128:131], v[184:187]
    v_mfma_f32_16x16x32_bf16 v[188:191], v[28:31], v[128:131], v[188:191]
    v_mfma_f32_16x16x32_bf16 v[192:195], v[16:19], v[132:135], v[192:195]
    v_mfma_f32_16x16x32_bf16 v[196:199], v[20:23], v[132:135], v[196:199]
    global_load_dwordx4 v[68:71], v61, s[12:13] offset:0 sc1
    v_mfma_f32_16x16x32_bf16 v[200:203], v[24:27], v[132:135], v[200:203]
    v_mfma_f32_16x16x32_bf16 v[204:207], v[28:31], v[132:135], v[204:207]
    v_mfma_f32_16x16x32_bf16 v[208:211], v[16:19], v[136:139], v[208:211]
    v_mfma_f32_16x16x32_bf16 v[212:215], v[20:23], v[136:139], v[212:215]
    global_load_dwordx4 v[72:75], v62, s[12:13] offset:0 sc1
    v_mfma_f32_16x16x32_bf16 v[216:219], v[24:27], v[136:139], v[216:219]
    v_mfma_f32_16x16x32_bf16 v[220:223], v[28:31], v[136:139], v[220:223]
    v_mfma_f32_16x16x32_bf16 v[224:227], v[16:19], v[140:143], v[224:227]
    v_mfma_f32_16x16x32_bf16 v[228:231], v[20:23], v[140:143], v[228:231]
    global_load_dwordx4 v[76:79], v63, s[12:13] offset:0 sc1
    v_mfma_f32_16x16x32_bf16 v[232:235], v[24:27], v[140:143], v[232:235]
    v_mfma_f32_16x16x32_bf16 v[236:239], v[28:31], v[140:143], v[236:239]
    s_waitcnt vmcnt(8)
    s_waitcnt lgkmcnt(0)
    ds_read_b64_tr_b16 v[16:17], v56 offset:16384
    ds_read_b64_tr_b16 v[18:19], v56 offset:17408
    ds_read_b64_tr_b16 v[20:21], v57 offset:16384
    ds_read_b64_tr_b16 v[22:23], v57 offset:17408
    ds_read_b64_tr_b16 v[24:25], v58 offset:16384
    ds_read_b64_tr_b16 v[26:27], v58 offset:17408
    ds_read_b64_tr_b16 v[28:29], v59 offset:16384
    ds_read_b64_tr_b16 v[30:31], v59 offset:17408
    v_mfma_f32_16x16x32_bf16 v[176:179], v[32:35], v[144:147], v[176:179]
    v_mfma_f32_16x16x32_bf16 v[180:183], v[36:39], v[144:147], v[180:183]
    s_bfe_u32 s57, s51, 0x40000
    s_lshl_b32 s57, s57, 10
    s_add_u32 s12, s10, s57
    s_addc_u32 s13, s11, 0
    global_load_dwordx4 v[80:83], v60, s[12:13] offset:0 sc1
    v_mfma_f32_16x16x32_bf16 v[184:187], v[40:43], v[144:147], v[184:187]
    v_mfma_f32_16x16x32_bf16 v[188:191], v[44:47], v[144:147], v[188:191]
    v_mfma_f32_16x16x32_bf16 v[192:195], v[32:35], v[148:151], v[192:195]
    v_mfma_f32_16x16x32_bf16 v[196:199], v[36:39], v[148:151], v[196:199]
    global_load_dwordx4 v[84:87], v61, s[12:13] offset:0 sc1
    v_mfma_f32_16x16x32_bf16 v[200:203], v[40:43], v[148:151], v[200:203]
    v_mfma_f32_16x16x32_bf16 v[204:207], v[44:47], v[148:151], v[204:207]
    v_mfma_f32_16x16x32_bf16 v[208:211], v[32:35], v[152:155], v[208:211]
    v_mfma_f32_16x16x32_bf16 v[212:215], v[36:39], v[152:155], v[212:215]
    global_load_dwordx4 v[88:91], v62, s[12:13] offset:0 sc1
    v_mfma_f32_16x16x32_bf16 v[216:219], v[40:43], v[152:155], v[216:219]
    v_mfma_f32_16x16x32_bf16 v[220:223], v[44:47], v[152:155], v[220:223]
    v_mfma_f32_16x16x32_bf16 v[224:227], v[32:35], v[156:159], v[224:227]
    v_mfma_f32_16x16x32_bf16 v[228:231], v[36:39], v[156:159], v[228:231]
    global_load_dwordx4 v[92:95], v63, s[12:13] offset:0 sc1
    v_mfma_f32_16x16x32_bf16 v[232:235], v[40:43], v[156:159], v[232:235]
    v_mfma_f32_16x16x32_bf16 v[236:239], v[44:47], v[156:159], v[236:239]
    s_waitcnt vmcnt(8)
    s_waitcnt lgkmcnt(0)
    ds_read_b64_tr_b16 v[32:33], v56 offset:32768
    ds_read_b64_tr_b16 v[34:35], v56 offset:33792
    ds_read_b64_tr_b16 v[36:37], v57 offset:32768
    ds_read_b64_tr_b16 v[38:39], v57 offset:33792
    ds_read_b64_tr_b16 v[40:41], v58 offset:32768
    ds_read_b64_tr_b16 v[42:43], v58 offset:33792
    ds_read_b64_tr_b16 v[44:45], v59 offset:32768
    ds_read_b64_tr_b16 v[46:47], v59 offset:33792
    v_mfma_f32_16x16x32_bf16 v[176:179], v[16:19], v[160:163], v[176:179]
    v_mfma_f32_16x16x32_bf16 v[180:183], v[20:23], v[160:163], v[180:183]
    s_bfe_u32 s57, s51, 0x40004
    s_lshl_b32 s57, s57, 10
    s_add_u32 s12, s10, s57
    s_addc_u32 s13, s11, 0
    global_load_dwordx4 v[96:99], v60, s[12:13] offset:0 sc1
    v_mfma_f32_16x16x32_bf16 v[184:187], v[24:27], v[160:163], v[184:187]
    v_mfma_f32_16x16x32_bf16 v[188:191], v[28:31], v[160:163], v[188:191]
    v_mfma_f32_16x16x32_bf16 v[192:195], v[16:19], v[164:167], v[192:195]
    v_mfma_f32_16x16x32_bf16 v[196:199], v[20:23], v[164:167], v[196:199]
    global_load_dwordx4 v[100:103], v61, s[12:13] offset:0 sc1
    v_mfma_f32_16x16x32_bf16 v[200:203], v[24:27], v[164:167], v[200:203]
    v_mfma_f32_16x16x32_bf16 v[204:207], v[28:31], v[164:167], v[204:207]
    v_mfma_f32_16x16x32_bf16 v[208:211], v[16:19], v[168:171], v[208:211]
    v_mfma_f32_16x16x32_bf16 v[212:215], v[20:23], v[168:171], v[212:215]
    global_load_dwordx4 v[104:107], v62, s[12:13] offset:0 sc1
    v_mfma_f32_16x16x32_bf16 v[216:219], v[24:27], v[168:171], v[216:219]
    v_mfma_f32_16x16x32_bf16 v[220:223], v[28:31], v[168:171], v[220:223]
    v_mfma_f32_16x16x32_bf16 v[224:227], v[16:19], v[172:175], v[224:227]
    v_mfma_f32_16x16x32_bf16 v[228:231], v[20:23], v[172:175], v[228:231]
    global_load_dwordx4 v[108:111], v63, s[12:13] offset:0 sc1
    v_mfma_f32_16x16x32_bf16 v[232:235], v[24:27], v[172:175], v[232:235]
    v_mfma_f32_16x16x32_bf16 v[236:239], v[28:31], v[172:175], v[236:239]
    s_waitcnt vmcnt(8)
    s_waitcnt lgkmcnt(0)
    v_add_u32 v56, 0xc000, v56
    v_add_u32 v57, 0xc000, v57
    v_add_u32 v58, 0xc000, v58
    v_add_u32 v59, 0xc000, v59
    ds_read_b64_tr_b16 v[16:17], v56 offset:0
    ds_read_b64_tr_b16 v[18:19], v56 offset:1024
    ds_read_b64_tr_b16 v[20:21], v57 offset:0
    ds_read_b64_tr_b16 v[22:23], v57 offset:1024
    ds_read_b64_tr_b16 v[24:25], v58 offset:0
    ds_read_b64_tr_b16 v[26:27], v58 offset:1024
    ds_read_b64_tr_b16 v[28:29], v59 offset:0
    ds_read_b64_tr_b16 v[30:31], v59 offset:1024
    v_mfma_f32_16x16x32_bf16 v[176:179], v[32:35], v[64:67], v[176:179]
    v_mfma_f32_16x16x32_bf16 v[180:183], v[36:39], v[64:67], v[180:183]
    s_bfe_u32 s57, s51, 0x40008
    s_lshl_b32 s57, s57, 10
    s_add_u32 s12, s10, s57
    s_addc_u32 s13, s11, 0
    global_load_dwordx4 v[112:115], v60, s[12:13] offset:0 sc1
    v_mfma_f32_16x16x32_bf16 v[184:187], v[40:43], v[64:67], v[184:187]
    v_mfma_f32_16x16x32_bf16 v[188:191], v[44:47], v[64:67], v[188:191]
    v_mfma_f32_16x16x32_bf16 v[192:195], v[32:35], v[68:71], v[192:195]
    v_mfma_f32_16x16x32_bf16 v[196:199], v[36:39], v[68:71], v[196:199]
    global_load_dwordx4 v[116:119], v61, s[12:13] offset:0 sc1
    v_mfma_f32_16x16x32_bf16 v[200:203], v[40:43], v[68:71], v[200:203]
    v_mfma_f32_16x16x32_bf16 v[204:207], v[44:47], v[68:71], v[204:207]
    v_mfma_f32_16x16x32_bf16 v[208:211], v[32:35], v[72:75], v[208:211]
    v_mfma_f32_16x16x32_bf16 v[212:215], v[36:39], v[72:75], v[212:215]
    global_load_dwordx4 v[120:123], v62, s[12:13] offset:0 sc1
    v_mfma_f32_16x16x32_bf16 v[216:219], v[40:43], v[72:75], v[216:219]
    v_mfma_f32_16x16x32_bf16 v[220:223], v[44:47], v[72:75], v[220:223]
    v_mfma_f32_16x16x32_bf16 v[224:227], v[32:35], v[76:79], v[224:227]
    v_mfma_f32_16x16x32_bf16 v[228:231], v[36:39], v[76:79], v[228:231]
    global_load_dwordx4 v[124:127], v63, s[12:13] offset:0 sc1
    v_mfma_f32_16x16x32_bf16 v[232:235], v[40:43], v[76:79], v[232:235]
    v_mfma_f32_16x16x32_bf16 v[236:239], v[44:47], v[76:79], v[236:239]
    s_waitcnt vmcnt(8)
    s_waitcnt lgkmcnt(0)
    ds_read_b64_tr_b16 v[32:33], v56 offset:16384
    ds_read_b64_tr_b16 v[34:35], v56 offset:17408
    ds_read_b64_tr_b16 v[36:37], v57 offset:16384
    ds_read_b64_tr_b16 v[38:39], v57 offset:17408
    ds_read_b64_tr_b16 v[40:41], v58 offset:16384
    ds_read_b64_tr_b16 v[42:43], v58 offset:17408
    ds_read_b64_tr_b16 v[44:45], v59 offset:16384
    ds_read_b64_tr_b16 v[46:47], v59 offset:17408
    v_mfma_f32_16x16x32_bf16 v[176:179], v[16:19], v[80:83], v[176:179]
    v_mfma_f32_16x16x32_bf16 v[180:183], v[20:23], v[80:83], v[180:183]
    global_load_dwordx2 v[144:145], v2, s[8:9] offset:0 sc1
    v_mfma_f32_16x16x32_bf16 v[184:187], v[24:27], v[80:83], v[184:187]
    v_mfma_f32_16x16x32_bf16 v[188:191], v[28:31], v[80:83], v[188:191]
    v_mfma_f32_16x16x32_bf16 v[192:195], v[16:19], v[84:87], v[192:195]
    v_mfma_f32_16x16x32_bf16 v[196:199], v[20:23], v[84:87], v[196:199]
    global_load_dwordx2 v[146:147], v2, s[8:9] offset:256 sc1
    v_mfma_f32_16x16x32_bf16 v[200:203], v[24:27], v[84:87], v[200:203]
    v_mfma_f32_16x16x32_bf16 v[204:207], v[28:31], v[84:87], v[204:207]
    v_mfma_f32_16x16x32_bf16 v[208:211], v[16:19], v[88:91], v[208:211]
    v_mfma_f32_16x16x32_bf16 v[212:215], v[20:23], v[88:91], v[212:215]
    global_load_dwordx2 v[148:149], v2, s[8:9] offset:512 sc1
    v_mfma_f32_16x16x32_bf16 v[216:219], v[24:27], v[88:91], v[216:219]
    v_mfma_f32_16x16x32_bf16 v[220:223], v[28:31], v[88:91], v[220:223]
    v_mfma_f32_16x16x32_bf16 v[224:227], v[16:19], v[92:95], v[224:227]
    v_mfma_f32_16x16x32_bf16 v[228:231], v[20:23], v[92:95], v[228:231]
    global_load_dwordx2 v[150:151], v2, s[8:9] offset:768 sc1
    v_mfma_f32_16x16x32_bf16 v[232:235], v[24:27], v[92:95], v[232:235]
    v_mfma_f32_16x16x32_bf16 v[236:239], v[28:31], v[92:95], v[236:239]
    s_waitcnt vmcnt(8)
    s_waitcnt lgkmcnt(0)
    ds_read_b64_tr_b16 v[16:17], v56 offset:32768
    ds_read_b64_tr_b16 v[18:19], v56 offset:33792
    ds_read_b64_tr_b16 v[20:21], v57 offset:32768
    ds_read_b64_tr_b16 v[22:23], v57 offset:33792
    ds_read_b64_tr_b16 v[24:25], v58 offset:32768
    ds_read_b64_tr_b16 v[26:27], v58 offset:33792
    ds_read_b64_tr_b16 v[28:29], v59 offset:32768
    ds_read_b64_tr_b16 v[30:31], v59 offset:33792
    v_mfma_f32_16x16x32_bf16 v[176:179], v[32:35], v[96:99], v[176:179]
    v_mfma_f32_16x16x32_bf16 v[180:183], v[36:39], v[96:99], v[180:183]
    global_load_dwordx4 v[240:243], v5, s[8:9] offset:0 sc1
    v_mfma_f32_16x16x32_bf16 v[184:187], v[40:43], v[96:99], v[184:187]
    v_mfma_f32_16x16x32_bf16 v[188:191], v[44:47], v[96:99], v[188:191]
    v_mfma_f32_16x16x32_bf16 v[192:195], v[32:35], v[100:103], v[192:195]
    v_mfma_f32_16x16x32_bf16 v[196:199], v[36:39], v[100:103], v[196:199]
    global_load_dwordx4 v[244:247], v5, s[8:9] offset:64 sc1
    v_mfma_f32_16x16x32_bf16 v[200:203], v[40:43], v[100:103], v[200:203]
    v_mfma_f32_16x16x32_bf16 v[204:207], v[44:47], v[100:103], v[204:207]
    v_mfma_f32_16x16x32_bf16 v[208:211], v[32:35], v[104:107], v[208:211]
    v_mfma_f32_16x16x32_bf16 v[212:215], v[36:39], v[104:107], v[212:215]
    global_load_dwordx4 v[248:251], v5, s[8:9] offset:128 sc1
    v_mfma_f32_16x16x32_bf16 v[216:219], v[40:43], v[104:107], v[216:219]
    v_mfma_f32_16x16x32_bf16 v[220:223], v[44:47], v[104:107], v[220:223]
    v_mfma_f32_16x16x32_bf16 v[224:227], v[32:35], v[108:111], v[224:227]
    v_mfma_f32_16x16x32_bf16 v[228:231], v[36:39], v[108:111], v[228:231]
    global_load_dwordx4 v[252:255], v5, s[8:9] offset:192 sc1
    v_mfma_f32_16x16x32_bf16 v[232:235], v[40:43], v[108:111], v[232:235]
    v_mfma_f32_16x16x32_bf16 v[236:239], v[44:47], v[108:111], v[236:239]
    s_waitcnt vmcnt(8)
    s_waitcnt lgkmcnt(0)
    v_mfma_f32_16x16x32_bf16 v[176:179], v[16:19], v[112:115], v[176:179]
    v_mfma_f32_16x16x32_bf16 v[180:183], v[20:23], v[112:115], v[180:183]
    v_mfma_f32_16x16x32_bf16 v[184:187], v[24:27], v[112:115], v[184:187]
    v_mfma_f32_16x16x32_bf16 v[188:191], v[28:31], v[112:115], v[188:191]
    v_mfma_f32_16x16x32_bf16 v[192:195], v[16:19], v[116:119], v[192:195]
    v_mfma_f32_16x16x32_bf16 v[196:199], v[20:23], v[116:119], v[196:199]
    v_mfma_f32_16x16x32_bf16 v[200:203], v[24:27], v[116:119], v[200:203]
    v_mfma_f32_16x16x32_bf16 v[204:207], v[28:31], v[116:119], v[204:207]
    v_mfma_f32_16x16x32_bf16 v[208:211], v[16:19], v[120:123], v[208:211]
    v_mfma_f32_16x16x32_bf16 v[212:215], v[20:23], v[120:123], v[212:215]
    v_mfma_f32_16x16x32_bf16 v[216:219], v[24:27], v[120:123], v[216:219]
    v_mfma_f32_16x16x32_bf16 v[220:223], v[28:31], v[120:123], v[220:223]
    ds_write_b128 v10, v[176:179] offset:0
    ds_write_b128 v10, v[180:183] offset:1024
    ds_write_b128 v10, v[184:187] offset:2048
    ds_write_b128 v10, v[188:191] offset:3072
    v_mfma_f32_16x16x32_bf16 v[224:227], v[16:19], v[124:127], v[224:227]
    v_mfma_f32_16x16x32_bf16 v[228:231], v[20:23], v[124:127], v[228:231]
    v_mfma_f32_16x16x32_bf16 v[232:235], v[24:27], v[124:127], v[232:235]
    v_mfma_f32_16x16x32_bf16 v[236:239], v[28:31], v[124:127], v[236:239]
    ds_write_b128 v10, v[192:195] offset:16384
    ds_write_b128 v10, v[196:199] offset:17408
    ds_write_b128 v10, v[200:203] offset:18432
    ds_write_b128 v10, v[204:207] offset:19456
    ds_write_b128 v10, v[208:211] offset:32768
    ds_write_b128 v10, v[212:215] offset:33792
    ds_write_b128 v10, v[216:219] offset:34816
    ds_write_b128 v10, v[220:223] offset:35840
    s_mov_b64 exec, 1
    ds_add_u32 v55, v11 offset:60
    s_mov_b64 exec, -1
    s_waitcnt vmcnt(0)
    v_lshlrev_b32 v112, 16, v144
    v_and_b32 v113, 0xffff0000, v144
    v_lshlrev_b32 v114, 16, v145
    v_and_b32 v115, 0xffff0000, v145
    v_lshlrev_b32 v116, 16, v146
    v_and_b32 v117, 0xffff0000, v146
    v_lshlrev_b32 v118, 16, v147
    v_and_b32 v119, 0xffff0000, v147
    v_lshlrev_b32 v120, 16, v148
    v_and_b32 v121, 0xffff0000, v148
    v_lshlrev_b32 v122, 16, v149
    v_and_b32 v123, 0xffff0000, v149
    v_lshlrev_b32 v124, 16, v150
    v_and_b32 v125, 0xffff0000, v150
    v_lshlrev_b32 v126, 16, v151
    v_and_b32 v127, 0xffff0000, v151
cde_s3:
    ds_read_b32 v53, v55 offset:60
    ds_read_b128 v[64:67], v13 offset:0
    ds_read_b128 v[68:71], v13 offset:1024
    ds_read_b128 v[72:75], v13 offset:2048
    ds_read_b128 v[76:79], v13 offset:3072
    ds_read_b128 v[80:83], v14 offset:0
    ds_read_b128 v[84:87], v14 offset:1024
    ds_read_b128 v[88:91], v14 offset:2048
    ds_read_b128 v[92:95], v14 offset:3072
    ds_read_b128 v[96:99], v15 offset:0
    ds_read_b128 v[100:103], v15 offset:1024
    ds_read_b128 v[104:107], v15 offset:2048
    ds_read_b128 v[108:111], v15 offset:3072
    s_waitcnt lgkmcnt(12)
    v_readfirstlane_b32 s15, v53
    s_nop 0
    s_cmp_ge_u32 s15, 4
    s_cbranch_scc0 cde_s3
    s_waitcnt lgkmcnt(8)
    v_pk_add_f32 v[224:225], v[224:225], v[64:65]
    v_pk_add_f32 v[226:227], v[226:227], v[66:67]
    v_pk_add_f32 v[228:229], v[228:229], v[68:69]
    v_pk_add_f32 v[230:231], v[230:231], v[70:71]
    v_pk_add_f32 v[232:233], v[232:233], v[72:73]
    v_pk_add_f32 v[234:235], v[234:235], v[74:75]
    v_pk_add_f32 v[236:237], v[236:237], v[76:77]
    v_pk_add_f32 v[238:239], v[238:239], v[78:79]
    s_waitcnt lgkmcnt(4)
    v_pk_add_f32 v[224:225], v[224:225], v[80:81]
    v_pk_add_f32 v[226:227], v[226:227], v[82:83]
    v_pk_add_f32 v[228:229], v[228:229], v[84:85]
    v_pk_add_f32 v[230:231], v[230:231], v[86:87]
    v_pk_add_f32 v[232:233], v[232:233], v[88:89]
    v_pk_add_f32 v[234:235], v[234:235], v[90:91]
    v_pk_add_f32 v[236:237], v[236:237], v[92:93]
    v_pk_add_f32 v[238:239], v[238:239], v[94:95]
    s_waitcnt lgkmcnt(0)
    v_pk_add_f32 v[224:225], v[224:225], v[96:97]
    v_pk_add_f32 v[226:227], v[226:227], v[98:99]
    v_pk_add_f32 v[228:229], v[228:229], v[100:101]
    v_pk_add_f32 v[230:231], v[230:231], v[102:103]
    v_pk_add_f32 v[232:233], v[232:233], v[104:105]
    v_pk_add_f32 v[234:235], v[234:235], v[106:107]
    v_pk_add_f32 v[236:237], v[236:237], v[108:109]
    v_pk_add_f32 v[238:239], v[238:239], v[110:111]
    v_pk_fma_f32 v[112:113], v[224:225], v[240:241], v[112:113]
    v_pk_fma_f32 v[114:115], v[226:227], v[242:243], v[114:115]
    v_pk_fma_f32 v[116:117], v[228:229], v[244:245], v[116:117]
    v_pk_fma_f32 v[118:119], v[230:231], v[246:247], v[118:119]
    v_pk_fma_f32 v[120:121], v[232:233], v[248:249], v[120:121]
    v_pk_fma_f32 v[122:123], v[234:235], v[250:251], v[122:123]
    v_pk_fma_f32 v[124:125], v[236:237], v[252:253], v[124:125]
    v_pk_fma_f32 v[126:127], v[238:239], v[254:255], v[126:127]
    v_cvt_pk_bf16_f32 v144, v112, v113
    v_cvt_pk_bf16_f32 v145, v114, v115
    v_cvt_pk_bf16_f32 v146, v116, v117
    v_cvt_pk_bf16_f32 v147, v118, v119
    v_cvt_pk_bf16_f32 v148, v120, v121
    v_cvt_pk_bf16_f32 v149, v122, v123
    v_cvt_pk_bf16_f32 v150, v124, v125
    v_cvt_pk_bf16_f32 v151, v126, v127
    v_permlane16_swap_b32 v144, v146
    v_permlane16_swap_b32 v145, v147
    v_permlane16_swap_b32 v148, v150
    v_permlane16_swap_b32 v149, v151
    global_store_dwordx4 v6, v[144:147], s[6:7] offset:0
    global_store_dwordx4 v6, v[148:151], s[6:7] offset:64
cde_end:
    s_endpgm
cde_sl15:
    global_store_dword v35, v11, s[36:37] offset:4 sc1
    s_branch cde_bk16
cde_sl19:
    global_store_dword v35, v11, s[36:37] offset:12 sc1
    s_branch cde_bk20
cde_sl21:
    global_store_dwordx4 v7, v[20:23], s[16:17] offset:0 nt sc1
    s_branch cde_bk22
cde_sl23:
    global_store_dwordx4 v7, v[24:27], s[16:17] offset:64 nt sc1
    s_branch cde_bk24
cde_sl25:
    global_store_dword v5, v11, s[36:37] sc1
    s_branch cde_bk26
cde_sl29:
    global_store_dword v53, v12, s[36:37] sc1
    s_branch cde_bk30
cde_last:
.section .rodata,"a"
.p2align 6
.amdhsa_kernel adaLN_cond__spectral_gfnet__dense_activation_silu__prompt_kernel
  .amdhsa_next_free_vgpr 256
  .amdhsa_next_free_sgpr 102
  .amdhsa_accum_offset 256
  .amdhsa_group_segment_fixed_size 0
  .amdhsa_kernarg_size 88
  .amdhsa_user_sgpr_count 2
  .amdhsa_user_sgpr_kernarg_segment_ptr 1
  .amdhsa_system_sgpr_workgroup_id_x 1
  .amdhsa_float_denorm_mode_32 3
.end_amdhsa_kernel
```
